```python
import torch

def _softmax(x, axis=-1):
    return torch.softmax(x, dim=axis)
def _gelu(x):
    return torch.nn.functional.gelu(x, approximate="tanh")
def _silu(x):
    return torch.nn.functional.silu(x)
def _sigmoid(x):
    return torch.sigmoid(x)
def _layernorm(x, axis=-1, eps=1e-5):
    m = x.mean(dim=axis, keepdim=True)
    v = x.var(dim=axis, keepdim=True, unbiased=False)
    return (x - m) / torch.sqrt(v + eps)
def _scatter_add(tgt, idx, src, axis=0):
    return tgt.clone().index_add_(axis, idx, src)
def _segment_sum(src, seg, n):
    out = torch.zeros((n,) + src.shape[1:], dtype=src.dtype)
    return out.index_add_(0, seg, src)
def _pad(x, pw):
    flat = tuple(v for pair in reversed(pw) for v in pair)
    return torch.nn.functional.pad(x, flat)

kernel_name = 'sequential_preLN__linear_kernel_hedgehog__swiglu_ffn__prompt'

def setup_inputs():

    _w = (lambda a: (lambda t: t.to(torch.bfloat16) if t.is_floating_point() else t)(torch.as_tensor(a)))
    def _A_setup():
        B, S, D, H = 1, 2048, 448, 16
        Dh = D // H
        return {
            "x": _w((lambda *s: torch.randn(*s, dtype=torch.bfloat16) * 0.05)(B, S, D)),
            "wqkv": _w((lambda *s: torch.randn(*s, dtype=torch.bfloat16) * 0.2)(D, 3 * D)),
            "w_phi": _w((lambda *s: torch.randn(*s, dtype=torch.bfloat16) * 0.2)(H, Dh, Dh) * (Dh ** -0.5)),
            "wo": _w((lambda *s: torch.randn(*s, dtype=torch.bfloat16) * 0.05)(D, D)),
        }
    _A_in = _A_setup()

    def _B_setup():
        B, S, D, F = 1, 2048, 448, 1792
        return {
            "x": _w((lambda *s: torch.randn(*s, dtype=torch.bfloat16) * 0.05)(B, S, D)),
            "w_gate": _w((lambda *s: torch.randn(*s, dtype=torch.bfloat16) * 0.05)(D, F)),
            "w_up": _w((lambda *s: torch.randn(*s, dtype=torch.bfloat16) * 0.05)(D, F)),
            "w_down": _w((lambda *s: torch.randn(*s, dtype=torch.bfloat16) * 0.05)(F, D)),
        }
    _B_in = _B_setup()

    return {
        "A_x": _A_in["x"],
        "A_wqkv": _A_in["wqkv"],
        "A_w_phi": _A_in["w_phi"],
        "A_wo": _A_in["wo"],
        "B_x": _B_in["x"],
        "B_w_gate": _B_in["w_gate"],
        "B_w_up": _B_in["w_up"],
        "B_w_down": _B_in["w_down"],
    }

def reference(A_x, A_wqkv, A_w_phi, A_wo, B_x, B_w_gate, B_w_up, B_w_down):
    def _A_ref(x, wqkv, w_phi, wo):
        B, S, D = x.shape
        H = 16; Dh = D // H
        qkv = (lambda x, *d: x.permute(*d))((x @ wqkv).reshape(B, S, 3, H, Dh), 2, 0, 3, 1, 4)
        q, k, v = qkv[0], qkv[1], qkv[2]
        pq = torch.einsum("bhsd,hdf->bhsf", q, w_phi)
        pk = torch.einsum("bhsd,hdf->bhsf", k, w_phi)
        phi_q = torch.concatenate([_softmax(pq, axis=-1), _softmax(-pq, axis=-1)], axis=-1)
        phi_k = torch.concatenate([_softmax(pk, axis=-1), _softmax(-pk, axis=-1)], axis=-1)
        kv = torch.einsum("bhsf,bhsd->bhfd", phi_k, v)
        z  = torch.einsum("bhsf->bhf", phi_k)
        num = torch.einsum("bhqf,bhfd->bhqd", phi_q, kv)
        den = torch.einsum("bhqf,bhf->bhq", phi_q, z)[..., None] + 1e-6
        o = num / den
        return (lambda x, *d: x.permute(*d))(o, 0, 2, 1, 3).reshape(B, S, D) @ wo

    def _B_ref(x, w_gate, w_up, w_down):
        g = _silu(x @ w_gate)
        u = x @ w_up
        return (g * u) @ w_down

    x = A_x
    h = x + _A_ref(_layernorm(x, axis=-1), A_wqkv, A_w_phi, A_wo)
    h2 = h + _B_ref(_layernorm(h, axis=-1), B_w_gate, B_w_up, B_w_down)
    return h2
```

```asm
; @launch grid=(256,1,1) block=(256,1,1) lds=163840
.amdgcn_target "amdgcn-amd-amdhsa--gfx950"
.text
.globl sequential_preLN__linear_kernel_hedgehog__swiglu_ffn__prompt_kernel
.p2align 8
.type sequential_preLN__linear_kernel_hedgehog__swiglu_ffn__prompt_kernel,@function
sequential_preLN__linear_kernel_hedgehog__swiglu_ffn__prompt_kernel:
    s_cmp_ge_u32 s2, 256
    s_cbranch_scc1 L_end
    s_load_dwordx16 s[4:19], s[0:1], 0
    s_load_dwordx2 s[20:21], s[0:1], 64
    s_load_dwordx2 s[24:25], s[0:1], 80
    v_lshrrev_b32 v1, 6, v0
    v_and_b32 v0, 63, v0
    v_readfirstlane_b32 s3, v1
    s_lshr_b32 s67, s2, 3
    s_and_b32 s68, s2, 7
    s_getpc_b64 s[50:51]
    s_mul_i32 s76, s67, 26
    s_lshr_b32 s76, s76, 8
    s_mul_i32 s76, s76, 10
    s_sub_u32 s76, s67, s76
    s_lshl_b32 s76, s76, 2
    s_add_u32 s76, s76, s3
    s_lshl_b32 s76, s76, 10
    v_lshl_add_u32 v1, v0, 4, s76
    global_load_dwordx4 v[184:187], v1, s[50:51]
    s_lshr_b32 s77, s68, 1
    s_lshl_b32 s77, s77, 3
    s_lshr_b32 s78, s67, 2
    s_add_u32 s77, s77, s78
    s_lshl_b32 s79, s77, 2
    s_add_u32 s79, s79, s3
    s_lshl_b32 s79, s79, 1
    s_and_b32 s82, s67, 1
    s_add_u32 s79, s79, s82
    s_xor_b32 s80, s79, 1
    s_mul_i32 s79, s79, 7168
    s_mul_i32 s80, s80, 7168
    v_lshrrev_b32 v226, 3, v0
    v_and_b32 v227, 7, v0
    v_mul_u32_u24 v228, 896, v226
    v_lshl_add_u32 v228, v227, 4, v228
    s_mov_b32 s30, 1835008
    s_mov_b32 s31, 0x20000
    s_mov_b32 s62, 0x10000000
    s_mov_b32 s63, 0x20000
    s_waitcnt lgkmcnt(0)
    s_mov_b32 s28, s4
    s_mov_b32 s29, s5
    s_mov_b32 s60, s24
    s_mov_b32 s61, s25
    s_nop 0
    buffer_load_dwordx4 v[128:131], v228, s[28:31], s79 offen offset:0
    buffer_load_dwordx4 v[132:135], v228, s[28:31], s79 offen offset:128
    buffer_load_dwordx4 v[136:139], v228, s[28:31], s79 offen offset:256
    buffer_load_dwordx4 v[140:143], v228, s[28:31], s79 offen offset:384
    buffer_load_dwordx4 v[144:147], v228, s[28:31], s79 offen offset:512
    buffer_load_dwordx4 v[148:151], v228, s[28:31], s79 offen offset:640
    buffer_load_dwordx4 v[152:155], v228, s[28:31], s79 offen offset:768
    s_mov_b32 s32, s6
    s_mov_b32 s33, s7
    s_mov_b32 s34, 1204224
    s_mov_b32 s35, 0x20000
    s_lshl_b32 s69, s2, 1
    s_lshr_b32 s78, s3, 1
    s_add_u32 s69, s69, s78
    s_and_b32 s64, s3, 1
    s_mul_i32 s76, s69, 2688
    s_mul_i32 s78, s64, 1792
    s_add_u32 s76, s76, s78
    v_mul_u32_u24 v4, 14, v0
    v_and_b32 v4, -4, v4
    buffer_load_dword v15, off, s[60:63], 0 sc1
    buffer_load_dwordx4 v[40:43], v4, s[32:35], s76 offen
    v_lshlrev_b32 v2, 4, v0
    s_mov_b32 s40, s10
    s_mov_b32 s41, s11
    s_mov_b32 s42, 401408
    s_mov_b32 s43, 0x20000
    s_lshl_b32 s79, s3, 8
    s_add_u32 s79, s79, s2
    s_mul_i32 s76, s79, 2688
    s_add_u32 s76, s76, 896
    s_sub_u32 s78, s79, 448
    s_lshl_b32 s78, s78, 10
    s_cmp_lt_u32 s79, 448
    s_cselect_b32 s36, s6, s10
    s_cselect_b32 s37, s7, s11
    s_cselect_b32 s38, s34, s42
    s_mov_b32 s39, 0x20000
    s_cselect_b32 s76, s76, s78
    buffer_load_dwordx4 v[188:191], v2, s[36:39], s76 offen
    s_cmp_lt_u32 s3, 2
    s_cselect_b32 s44, s14, s16
    s_cselect_b32 s45, s15, s17
    s_mov_b32 s46, 1605632
    s_mov_b32 s47, 0x20000
    s_and_b32 s76, s68, 1
    s_lshl_b32 s76, s76, 2
    s_and_b32 s78, s67, 3
    s_add_u32 s76, s76, s78
    s_lshl_b32 s65, s77, 1
    s_lshr_b32 s78, s3, 1
    s_add_u32 s65, s65, s78
    s_mul_i32 s4, s78, 0x80008000
    s_lshl_b32 s66, s76, 1
    s_and_b32 s78, s3, 1
    s_add_u32 s66, s66, s78
    s_mov_b32 s52, s18
    s_mul_i32 s88, s76, 112
    s_mul_i32 s78, s3, 86016
    s_add_u32 s12, s88, s78
    s_mul_i32 s78, s3, 215040
    s_add_u32 s88, s88, s78
    s_mul_i32 s13, s3, 10240
    s_lshl_b32 s23, s3, 12
    s_mul_i32 s87, s3, 7168
    s_mul_i32 s90, s3, 14336
    s_mul_i32 s18, s76, 57344
    s_mul_i32 s76, s76, 3136
    s_mov_b32 s53, s19
    s_add_u32 s17, s18, s13
    s_add_u32 s18, s18, s23
    s_mul_i32 s19, s64, 458752
    s_lshl_b32 s78, s69, 7
    s_add_u32 s19, s19, s78
    s_add_u32 s19, s19, 4194304
    s_cmp_lt_u32 s69, 448
    s_cselect_b32 s19, s19, 2146435072
    s_and_b32 s78, s69, 2
    s_lshl_b32 s78, s78, 5
    v_mul_u32_u24 v49, 57344, v226
    v_lshl_add_u32 v49, v227, 4, v49
    v_xor_b32 v49, s78, v49
    v_and_b32_e64 v51, 16, v2
    s_mov_b32 s36, s8
    s_mov_b32 s37, s9
    s_mov_b32 s38, 25088
    s_mov_b32 s39, 0x20000
    s_mov_b32 s54, 1605632
    s_mov_b32 s55, 0x20000
    s_mov_b32 s56, s20
    s_mov_b32 s57, s21
    s_mov_b32 s58, 1835008
    s_mov_b32 s59, 0x20000
    s_mov_b32 s70, 0x3fb8aa3b
    s_mov_b32 s71, 0xffff0000
    s_mov_b32 s72, 0
    s_mov_b32 s73, -1
    s_mov_b32 s85, 0x07060302
    s_mov_b32 s84, 300000
    s_mul_i32 s77, s67, 37
    s_lshr_b32 s77, s77, 8
    s_mul_i32 s78, s77, 7
    s_sub_u32 s27, s67, s78
    s_lshl_b32 s83, s68, 2
    s_add_u32 s83, s83, s77
    s_lshl_b32 s93, s83, 1
    s_lshr_b32 s78, s3, 1
    s_add_u32 s93, s93, s78
    s_lshl_b32 s94, s27, 1
    s_and_b32 s78, s3, 1
    s_add_u32 s94, s94, s78
    s_lshr_b32 s95, s68, 1
    s_lshl_b32 s95, s95, 2
    s_add_u32 s95, s95, s77
    s_and_b32 s26, s68, 1
    s_mul_i32 s26, s26, 7
    s_add_u32 s26, s26, s27
    s_lshl_b32 s89, s26, 8
    s_lshl_b32 s78, s78, 7
    s_add_u32 s89, s89, s78
    s_mul_i32 s91, s3, 401408
    s_lshl_b32 s78, s27, 7
    s_add_u32 s91, s91, s78
    s_cmp_lt_u32 s67, 28
    s_cselect_b32 s25, 0, 2146435072
    s_mul_i32 s5, s93, 14
    s_add_u32 s5, s5, s94
    v_lshrrev_b32 v7, 5, v0
    v_and_b32 v8, 31, v0
    v_mov_b32 v10, 2146435072
    v_lshlrev_b32 v14, 2, v0
    v_cmp_gt_u32 vcc, 16, v0
    s_nop 1
    v_cndmask_b32 v14, v10, v14, vcc
    v_bfe_u32 v4, v0, 4, 1
    v_lshlrev_b32 v4, 6, v4
    v_and_b32 v5, 0x70, v2
    v_xor_b32 v4, v4, v5
    v_lshrrev_b32 v1, 3, v0
    v_mul_u32_u24 v1, 2688, v1
    v_add_u32 v1, v1, v4
    v_cmp_eq_u32 vcc, 0x70, v4
    v_mov_b32 v5, 2146435072
    s_nop 0
    v_cndmask_b32 v1, v1, v5, vcc
    v_add_u32 v4, 20480, v1
    v_add_u32 v5, 40960, v1
    v_add_u32 v6, 61440, v1
    s_lshr_b32 s78, s3, 1
    s_lshl_b32 s78, s78, 9
    s_add_u32 s78, s78, 98304
    v_mul_u32_u24 v9, 1040, v7
    v_lshl_add_u32 v9, v8, 4, v9
    v_add_u32 v9, s78, v9
    s_and_b32 s77, s3, 1
    s_lshl_b32 s77, s77, 8
    s_add_u32 s78, s78, s77
    v_mul_u32_u24 v12, 1040, v227
    v_lshl_add_u32 v12, v226, 4, v12
    s_lshl_b32 s82, s82, 7
    s_add_u32 s77, s78, s82
    s_xor_b32 s82, s82, 128
    s_add_u32 s78, s78, s82
    v_add_u32 v231, s78, v12
    v_add_u32 v12, s77, v12
    v_bfe_u32 v248, v0, 2, 2
    v_bfe_u32 v249, v0, 4, 1
    v_and_b32 v250, 3, v0
    v_lshlrev_b32 v253, 3, v250
    v_lshl_add_u32 v253, v249, 5, v253
    v_bfe_u32 v251, v0, 3, 1
    v_lshl_add_u32 v254, v251, 2, v250
    v_lshlrev_b32 v251, 6, v251
    s_and_b32 s78, s3, 1
    s_mul_i32 s77, s78, 56
    v_add_u32 v10, s77, v253
    v_xor_b32 v10, v10, v251
    v_lshl_add_u32 v252, v7, 3, v248
    v_lshl_add_u32 v10, v252, 7, v10
    s_lshl_b32 s77, s78, 6
    v_and_b32 v11, 1, v0
    v_lshl_add_u32 v11, v249, 1, v11
    v_bfe_u32 v229, v0, 1, 1
    v_lshl_add_u32 v11, v11, 1, v229
    v_lshl_add_u32 v11, v11, 3, s77
    v_xor_b32 v11, v11, v251
    v_lshl_add_u32 v11, v252, 7, v11
    v_add_u32 v11, 57344, v11
    v_xor_b32 v3, v253, v251
    v_lshl_add_u32 v252, v7, 2, v248
    v_lshl_add_u32 v3, v252, 7, v3
    v_bfe_u32 v252, v0, 2, 1
    v_lshl_add_u32 v252, v249, 1, v252
    v_mad_u32_u24 v252, v252, 7, v254
    v_mul_u32_u24 v230, 224, v7
    v_lshl_add_u32 v230, v252, 1, v230
    s_mul_i32 s78, s78, 1568
    s_add_u32 s78, s78, 157440
    v_add_u32 v230, s78, v230
    v_mul_u32_u24 v229, 168, v7
    v_add_u32 v229, v229, v230
    s_mul_i32 s78, s66, 139264
    s_add_u32 s78, s78, 1048576
    s_mul_i32 s6, s65, 2176
    s_add_u32 s6, s6, s78
    s_lshr_b32 s77, s65, 1
    s_lshl_b32 s77, s77, 6
    s_add_u32 s78, s78, s77
    s_lshr_b32 s20, s3, 1
    s_mul_i32 s77, s20, 69632
    s_add_u32 s7, s78, s77
    s_add_u32 s8, s7, 34816
    s_mul_i32 s9, s93, 28672
    s_lshl_b32 s77, s94, 6
    s_add_u32 s9, s9, s77
    s_add_u32 s9, s9, s25
    s_lshl_b32 s10, s66, 12
    s_add_u32 s10, s10, 65536
    s_lshl_b32 s11, s65, 6
    s_add_u32 s11, s11, s10
    s_lshl_b32 s14, s5, 11
    s_add_u32 s14, s14, 8388608
    s_add_u32 s14, s14, s25
    s_lshl_b32 s15, s93, 4
    s_add_u32 s15, s15, s94
    s_lshl_b32 s15, s15, 8
    s_add_u32 s15, s15, 131072
    s_add_u32 s15, s15, s25
    v_lshrrev_b32 v224, 2, v0
    v_mul_u32_u24 v224, 896, v224
    v_and_b32 v225, 48, v2
    v_add_u32 v224, v224, v225
    v_add_u32 v225, 13312, v224
    s_add_u32 s77, s23, 114688
    v_lshlrev_b32 v219, 6, v8
    v_lshl_add_u32 v219, v7, 3, v219
    v_add_u32_e64 v219, s77, v219
    v_accvgpr_write_b32 a236, -1
    v_accvgpr_write_b32 a237, -1
    v_accvgpr_write_b32 a238, -1
    v_accvgpr_write_b32 a239, -1
    v_lshrrev_b32 v218, 2, v0
    v_mul_u32_u24 v218, 2176, v218
    v_and_b32 v217, 48, v2
    v_add_u32 v218, v218, v217
    s_and_b32 s50, s93, 2
    s_cselect_b32 s50, 2146435072, s14
    v_mov_b32 v16, 0x3f803f80
    buffer_load_dwordx4 v[156:159], v228, s[28:31], s80 offen offset:0
    buffer_load_dwordx4 v[160:163], v228, s[28:31], s80 offen offset:128
    buffer_load_dwordx4 v[164:167], v228, s[28:31], s80 offen offset:256
    buffer_load_dwordx4 v[168:171], v228, s[28:31], s80 offen offset:384
    buffer_load_dwordx4 v[172:175], v228, s[28:31], s80 offen offset:512
    buffer_load_dwordx4 v[176:179], v228, s[28:31], s80 offen offset:640
    buffer_load_dwordx4 v[180:183], v228, s[28:31], s80 offen offset:768
    s_waitcnt vmcnt(16)
    v_mov_b32 v248, 0
    v_mov_b32 v249, 0
    v_dot2c_f32_bf16 v248, v128, v16
    v_dot2c_f32_bf16 v249, v128, v128
    v_dot2c_f32_bf16 v248, v129, v16
    v_dot2c_f32_bf16 v249, v129, v129
    v_dot2c_f32_bf16 v248, v130, v16
    v_dot2c_f32_bf16 v249, v130, v130
    v_dot2c_f32_bf16 v248, v131, v16
    v_dot2c_f32_bf16 v249, v131, v131
    s_waitcnt vmcnt(15)
    v_dot2c_f32_bf16 v248, v132, v16
    v_dot2c_f32_bf16 v249, v132, v132
    v_dot2c_f32_bf16 v248, v133, v16
    v_dot2c_f32_bf16 v249, v133, v133
    v_dot2c_f32_bf16 v248, v134, v16
    v_dot2c_f32_bf16 v249, v134, v134
    v_dot2c_f32_bf16 v248, v135, v16
    v_dot2c_f32_bf16 v249, v135, v135
    s_waitcnt vmcnt(14)
    v_dot2c_f32_bf16 v248, v136, v16
    v_dot2c_f32_bf16 v249, v136, v136
    v_dot2c_f32_bf16 v248, v137, v16
    v_dot2c_f32_bf16 v249, v137, v137
    v_dot2c_f32_bf16 v248, v138, v16
    v_dot2c_f32_bf16 v249, v138, v138
    v_dot2c_f32_bf16 v248, v139, v16
    v_dot2c_f32_bf16 v249, v139, v139
    s_waitcnt vmcnt(13)
    s_add_u32 m0, s13, 0
    s_add_u32 s81, s88, 896
    buffer_load_dwordx4 v1, s[32:35], s81 offen offset:0  lds
    v_dot2c_f32_bf16 v248, v140, v16
    v_dot2c_f32_bf16 v249, v140, v140
    v_dot2c_f32_bf16 v248, v141, v16
    v_dot2c_f32_bf16 v249, v141, v141
    v_dot2c_f32_bf16 v248, v142, v16
    v_dot2c_f32_bf16 v249, v142, v142
    v_dot2c_f32_bf16 v248, v143, v16
    v_dot2c_f32_bf16 v249, v143, v143
    s_waitcnt vmcnt(13)
    v_dot2c_f32_bf16 v248, v144, v16
    v_dot2c_f32_bf16 v249, v144, v144
    v_dot2c_f32_bf16 v248, v145, v16
    v_dot2c_f32_bf16 v249, v145, v145
    v_dot2c_f32_bf16 v248, v146, v16
    v_dot2c_f32_bf16 v249, v146, v146
    v_dot2c_f32_bf16 v248, v147, v16
    v_dot2c_f32_bf16 v249, v147, v147
    s_waitcnt vmcnt(12)
    v_dot2c_f32_bf16 v248, v148, v16
    v_dot2c_f32_bf16 v249, v148, v148
    v_dot2c_f32_bf16 v248, v149, v16
    v_dot2c_f32_bf16 v249, v149, v149
    v_dot2c_f32_bf16 v248, v150, v16
    v_dot2c_f32_bf16 v249, v150, v150
    v_dot2c_f32_bf16 v248, v151, v16
    v_dot2c_f32_bf16 v249, v151, v151
    s_waitcnt vmcnt(11)
    buffer_load_dwordx4 v4, s[32:35], s81 offen offset:1024  lds
    buffer_load_dwordx4 v5, s[32:35], s81 offen offset:2048  lds
    v_dot2c_f32_bf16 v248, v152, v16
    v_dot2c_f32_bf16 v249, v152, v152
    v_dot2c_f32_bf16 v248, v153, v16
    v_dot2c_f32_bf16 v249, v153, v153
    v_dot2c_f32_bf16 v248, v154, v16
    v_dot2c_f32_bf16 v249, v154, v154
    v_dot2c_f32_bf16 v248, v155, v16
    v_dot2c_f32_bf16 v249, v155, v155
    s_waitcnt vmcnt(11)
    v_readfirstlane_b32 s64, v15
    v_alignbit_b32 v40, v41, v40, v51
    s_lshr_b32 s64, s64, 16
    s_add_u32 s64, s64, 0xa5b
    s_and_b32 s64, s64, 0x1fff
    s_or_b32 s69, s64, 0x2000
    s_lshl_b32 s86, s69, 16
    s_or_b32 s69, s69, s86
    s_or_b32 s64, s86, 0x5a3c
    v_mov_b32 v15, s64
    v_alignbit_b32 v41, v42, v41, v51
    v_alignbit_b32 v42, v43, v42, v51
    v_lshrrev_b32_e64 v43, v51, v43
    v_bfi_b32 v43, s71, v15, v43
    buffer_store_dwordx4 v[40:43], v49, s[60:63], s19 offen sc1
    v_add_f32_dpp v248, v248, v248 quad_perm:[1,0,3,2] row_mask:0xf bank_mask:0xf
    v_add_f32_dpp v249, v249, v249 quad_perm:[1,0,3,2] row_mask:0xf bank_mask:0xf
    s_nop 0
    v_add_f32_dpp v248, v248, v248 quad_perm:[2,3,0,1] row_mask:0xf bank_mask:0xf
    v_add_f32_dpp v249, v249, v249 quad_perm:[2,3,0,1] row_mask:0xf bank_mask:0xf
    s_nop 0
    v_add_f32_dpp v248, v248, v248 row_half_mirror row_mask:0xf bank_mask:0xf
    v_add_f32_dpp v249, v249, v249 row_half_mirror row_mask:0xf bank_mask:0xf
    v_mul_f32 v248, 991054117, v248
    v_mul_f32 v249, 991054117, v249
    v_fma_f32 v249, -v248, v248, v249
    v_max_f32 v249, 0, v249
    v_add_f32 v249, 0x3727c5ac, v249
    v_rsq_f32 v249, v249
    s_nop 0
    v_cvt_pk_bf16_f32 v250, v249, 0
    v_lshlrev_b32 v251, 16, v250
    v_mul_f32_e64 v252, -v248, v251
    v_dot2_f32_bf16 v24, v128, v250, v252
    v_dot2_f32_bf16 v25, v128, v251, v252
    v_dot2_f32_bf16 v26, v129, v250, v252
    v_dot2_f32_bf16 v27, v129, v251, v252
    v_dot2_f32_bf16 v28, v130, v250, v252
    v_dot2_f32_bf16 v29, v130, v251, v252
    v_dot2_f32_bf16 v30, v131, v250, v252
    v_dot2_f32_bf16 v31, v131, v251, v252
    v_dot2_f32_bf16 v32, v132, v250, v252
    v_dot2_f32_bf16 v33, v132, v251, v252
    v_dot2_f32_bf16 v34, v133, v250, v252
    v_dot2_f32_bf16 v35, v133, v251, v252
    v_dot2_f32_bf16 v36, v134, v250, v252
    v_dot2_f32_bf16 v37, v134, v251, v252
    v_dot2_f32_bf16 v38, v135, v250, v252
    v_dot2_f32_bf16 v39, v135, v251, v252
    v_cvt_pk_bf16_f32 v128, v24, v25
    v_cvt_pk_bf16_f32 v129, v26, v27
    v_cvt_pk_bf16_f32 v130, v28, v29
    v_cvt_pk_bf16_f32 v131, v30, v31
    buffer_load_dwordx4 v6, s[32:35], s81 offen offset:3072  lds
    ds_write_b128 v12, v[128:131] offset:0
    v_dot2_f32_bf16 v24, v136, v250, v252
    v_dot2_f32_bf16 v25, v136, v251, v252
    v_dot2_f32_bf16 v26, v137, v250, v252
    v_dot2_f32_bf16 v27, v137, v251, v252
    v_dot2_f32_bf16 v28, v138, v250, v252
    v_dot2_f32_bf16 v29, v138, v251, v252
    v_dot2_f32_bf16 v30, v139, v250, v252
    v_dot2_f32_bf16 v31, v139, v251, v252
    v_cvt_pk_bf16_f32 v132, v32, v33
    v_cvt_pk_bf16_f32 v133, v34, v35
    v_cvt_pk_bf16_f32 v134, v36, v37
    v_cvt_pk_bf16_f32 v135, v38, v39
    s_add_u32 m0, s13, 4096
    s_add_u32 s81, s88, 86912
    buffer_load_dwordx4 v1, s[32:35], s81 offen offset:0  lds
    ds_write_b128 v12, v[132:135] offset:8320
    v_dot2_f32_bf16 v32, v140, v250, v252
    v_dot2_f32_bf16 v33, v140, v251, v252
    v_dot2_f32_bf16 v34, v141, v250, v252
    v_dot2_f32_bf16 v35, v141, v251, v252
    v_dot2_f32_bf16 v36, v142, v250, v252
    v_dot2_f32_bf16 v37, v142, v251, v252
    v_dot2_f32_bf16 v38, v143, v250, v252
    v_dot2_f32_bf16 v39, v143, v251, v252
    v_cvt_pk_bf16_f32 v136, v24, v25
    v_cvt_pk_bf16_f32 v137, v26, v27
    v_cvt_pk_bf16_f32 v138, v28, v29
    v_cvt_pk_bf16_f32 v139, v30, v31
    buffer_load_dwordx4 v4, s[32:35], s81 offen offset:1024  lds
    ds_write_b128 v12, v[136:139] offset:16640
    v_dot2_f32_bf16 v24, v144, v250, v252
    v_dot2_f32_bf16 v25, v144, v251, v252
    v_dot2_f32_bf16 v26, v145, v250, v252
    v_dot2_f32_bf16 v27, v145, v251, v252
    v_dot2_f32_bf16 v28, v146, v250, v252
    v_dot2_f32_bf16 v29, v146, v251, v252
    v_dot2_f32_bf16 v30, v147, v250, v252
    v_dot2_f32_bf16 v31, v147, v251, v252
    v_cvt_pk_bf16_f32 v140, v32, v33
    v_cvt_pk_bf16_f32 v141, v34, v35
    v_cvt_pk_bf16_f32 v142, v36, v37
    v_cvt_pk_bf16_f32 v143, v38, v39
    ds_write_b128 v12, v[140:143] offset:24960
    v_dot2_f32_bf16 v32, v148, v250, v252
    v_dot2_f32_bf16 v33, v148, v251, v252
    v_dot2_f32_bf16 v34, v149, v250, v252
    v_dot2_f32_bf16 v35, v149, v251, v252
    v_dot2_f32_bf16 v36, v150, v250, v252
    v_dot2_f32_bf16 v37, v150, v251, v252
    v_dot2_f32_bf16 v38, v151, v250, v252
    v_dot2_f32_bf16 v39, v151, v251, v252
    v_cvt_pk_bf16_f32 v144, v24, v25
    v_cvt_pk_bf16_f32 v145, v26, v27
    v_cvt_pk_bf16_f32 v146, v28, v29
    v_cvt_pk_bf16_f32 v147, v30, v31
    buffer_load_dwordx4 v5, s[32:35], s81 offen offset:2048  lds
    ds_write_b128 v12, v[144:147] offset:33280
    v_dot2_f32_bf16 v24, v152, v250, v252
    v_dot2_f32_bf16 v25, v152, v251, v252
    v_dot2_f32_bf16 v26, v153, v250, v252
    v_dot2_f32_bf16 v27, v153, v251, v252
    v_dot2_f32_bf16 v28, v154, v250, v252
    v_dot2_f32_bf16 v29, v154, v251, v252
    v_dot2_f32_bf16 v30, v155, v250, v252
    v_dot2_f32_bf16 v31, v155, v251, v252
    v_cvt_pk_bf16_f32 v148, v32, v33
    v_cvt_pk_bf16_f32 v149, v34, v35
    v_cvt_pk_bf16_f32 v150, v36, v37
    v_cvt_pk_bf16_f32 v151, v38, v39
    ds_write_b128 v12, v[148:151] offset:41600
    v_cvt_pk_bf16_f32 v152, v24, v25
    v_cvt_pk_bf16_f32 v153, v26, v27
    v_cvt_pk_bf16_f32 v154, v28, v29
    v_cvt_pk_bf16_f32 v155, v30, v31
    buffer_load_dwordx4 v6, s[32:35], s81 offen offset:3072  lds
    ds_write_b128 v12, v[152:155] offset:49920
    s_waitcnt vmcnt(15)
    s_add_u32 m0, s13, 8192
    s_add_u32 s81, s88, 172928
    buffer_load_dwordx4 v1, s[32:35], s81 offen offset:0  lds
    v_mov_b32 v248, 0
    v_mov_b32 v249, 0
    v_dot2c_f32_bf16 v248, v156, v16
    v_dot2c_f32_bf16 v249, v156, v156
    v_dot2c_f32_bf16 v248, v157, v16
    v_dot2c_f32_bf16 v249, v157, v157
    v_dot2c_f32_bf16 v248, v158, v16
    v_dot2c_f32_bf16 v249, v158, v158
    v_dot2c_f32_bf16 v248, v159, v16
    v_dot2c_f32_bf16 v249, v159, v159
    s_waitcnt vmcnt(15)
    v_dot2c_f32_bf16 v248, v160, v16
    v_dot2c_f32_bf16 v249, v160, v160
    v_dot2c_f32_bf16 v248, v161, v16
    v_dot2c_f32_bf16 v249, v161, v161
    v_dot2c_f32_bf16 v248, v162, v16
    v_dot2c_f32_bf16 v249, v162, v162
    v_dot2c_f32_bf16 v248, v163, v16
    v_dot2c_f32_bf16 v249, v163, v163
    s_waitcnt vmcnt(14)
    v_dot2c_f32_bf16 v248, v164, v16
    v_dot2c_f32_bf16 v249, v164, v164
    v_dot2c_f32_bf16 v248, v165, v16
    v_dot2c_f32_bf16 v249, v165, v165
    v_dot2c_f32_bf16 v248, v166, v16
    v_dot2c_f32_bf16 v249, v166, v166
    v_dot2c_f32_bf16 v248, v167, v16
    v_dot2c_f32_bf16 v249, v167, v167
    s_waitcnt vmcnt(13)
    v_dot2c_f32_bf16 v248, v168, v16
    v_dot2c_f32_bf16 v249, v168, v168
    v_dot2c_f32_bf16 v248, v169, v16
    v_dot2c_f32_bf16 v249, v169, v169
    v_dot2c_f32_bf16 v248, v170, v16
    v_dot2c_f32_bf16 v249, v170, v170
    v_dot2c_f32_bf16 v248, v171, v16
    v_dot2c_f32_bf16 v249, v171, v171
    s_waitcnt vmcnt(12)
    buffer_load_dwordx4 v4, s[32:35], s81 offen offset:1024  lds
    v_dot2c_f32_bf16 v248, v172, v16
    v_dot2c_f32_bf16 v249, v172, v172
    v_dot2c_f32_bf16 v248, v173, v16
    v_dot2c_f32_bf16 v249, v173, v173
    v_dot2c_f32_bf16 v248, v174, v16
    v_dot2c_f32_bf16 v249, v174, v174
    v_dot2c_f32_bf16 v248, v175, v16
    v_dot2c_f32_bf16 v249, v175, v175
    s_waitcnt vmcnt(12)
    v_dot2c_f32_bf16 v248, v176, v16
    v_dot2c_f32_bf16 v249, v176, v176
    v_dot2c_f32_bf16 v248, v177, v16
    v_dot2c_f32_bf16 v249, v177, v177
    v_dot2c_f32_bf16 v248, v178, v16
    v_dot2c_f32_bf16 v249, v178, v178
    v_dot2c_f32_bf16 v248, v179, v16
    v_dot2c_f32_bf16 v249, v179, v179
    s_waitcnt vmcnt(11)
    v_dot2c_f32_bf16 v248, v180, v16
    v_dot2c_f32_bf16 v249, v180, v180
    v_dot2c_f32_bf16 v248, v181, v16
    v_dot2c_f32_bf16 v249, v181, v181
    v_dot2c_f32_bf16 v248, v182, v16
    v_dot2c_f32_bf16 v249, v182, v182
    v_dot2c_f32_bf16 v248, v183, v16
    v_dot2c_f32_bf16 v249, v183, v183
    s_nop 1
    v_add_f32_dpp v248, v248, v248 quad_perm:[1,0,3,2] row_mask:0xf bank_mask:0xf
    v_add_f32_dpp v249, v249, v249 quad_perm:[1,0,3,2] row_mask:0xf bank_mask:0xf
    s_nop 0
    v_add_f32_dpp v248, v248, v248 quad_perm:[2,3,0,1] row_mask:0xf bank_mask:0xf
    v_add_f32_dpp v249, v249, v249 quad_perm:[2,3,0,1] row_mask:0xf bank_mask:0xf
    s_nop 0
    v_add_f32_dpp v248, v248, v248 row_half_mirror row_mask:0xf bank_mask:0xf
    v_add_f32_dpp v249, v249, v249 row_half_mirror row_mask:0xf bank_mask:0xf
    v_mul_f32 v248, 991054117, v248
    v_mul_f32 v249, 991054117, v249
    v_fma_f32 v249, -v248, v248, v249
    v_max_f32 v249, 0, v249
    v_add_f32 v249, 0x3727c5ac, v249
    v_rsq_f32 v249, v249
    s_nop 0
    v_cvt_pk_bf16_f32 v250, v249, 0
    v_lshlrev_b32 v251, 16, v250
    v_mul_f32_e64 v252, -v248, v251
    v_dot2_f32_bf16 v24, v156, v250, v252
    v_dot2_f32_bf16 v25, v156, v251, v252
    v_dot2_f32_bf16 v26, v157, v250, v252
    v_dot2_f32_bf16 v27, v157, v251, v252
    v_dot2_f32_bf16 v28, v158, v250, v252
    v_dot2_f32_bf16 v29, v158, v251, v252
    v_dot2_f32_bf16 v30, v159, v250, v252
    v_dot2_f32_bf16 v31, v159, v251, v252
    v_dot2_f32_bf16 v32, v160, v250, v252
    v_dot2_f32_bf16 v33, v160, v251, v252
    v_dot2_f32_bf16 v34, v161, v250, v252
    v_dot2_f32_bf16 v35, v161, v251, v252
    v_dot2_f32_bf16 v36, v162, v250, v252
    v_dot2_f32_bf16 v37, v162, v251, v252
    v_dot2_f32_bf16 v38, v163, v250, v252
    v_dot2_f32_bf16 v39, v163, v251, v252
    v_cvt_pk_bf16_f32 v156, v24, v25
    v_cvt_pk_bf16_f32 v157, v26, v27
    v_cvt_pk_bf16_f32 v158, v28, v29
    v_cvt_pk_bf16_f32 v159, v30, v31
    s_lshl_b32 s79, s3, 10
    s_add_u32 m0, s79, 157440
    s_add_u32 s76, s76, s79
    buffer_load_dwordx4 v2, s[36:39], s76 offen lds
    s_add_u32 m0, s23, 40960
    s_add_u32 s81, s12, 861056
    buffer_load_dwordx4 v1, s[32:35], s81 offen offset:0  lds
    ds_write_b128 v231, v[156:159] offset:0
    v_dot2_f32_bf16 v24, v164, v250, v252
    v_dot2_f32_bf16 v25, v164, v251, v252
    v_dot2_f32_bf16 v26, v165, v250, v252
    v_dot2_f32_bf16 v27, v165, v251, v252
    v_dot2_f32_bf16 v28, v166, v250, v252
    v_dot2_f32_bf16 v29, v166, v251, v252
    v_dot2_f32_bf16 v30, v167, v250, v252
    v_dot2_f32_bf16 v31, v167, v251, v252
    v_cvt_pk_bf16_f32 v160, v32, v33
    v_cvt_pk_bf16_f32 v161, v34, v35
    v_cvt_pk_bf16_f32 v162, v36, v37
    v_cvt_pk_bf16_f32 v163, v38, v39
    ds_write_b128 v231, v[160:163] offset:8320
    v_dot2_f32_bf16 v32, v168, v250, v252
    v_dot2_f32_bf16 v33, v168, v251, v252
    v_dot2_f32_bf16 v34, v169, v250, v252
    v_dot2_f32_bf16 v35, v169, v251, v252
    v_dot2_f32_bf16 v36, v170, v250, v252
    v_dot2_f32_bf16 v37, v170, v251, v252
    v_dot2_f32_bf16 v38, v171, v250, v252
    v_dot2_f32_bf16 v39, v171, v251, v252
    v_cvt_pk_bf16_f32 v164, v24, v25
    v_cvt_pk_bf16_f32 v165, v26, v27
    v_cvt_pk_bf16_f32 v166, v28, v29
    v_cvt_pk_bf16_f32 v167, v30, v31
    buffer_load_dwordx4 v4, s[32:35], s81 offen offset:1024  lds
    ds_write_b128 v231, v[164:167] offset:16640
    v_dot2_f32_bf16 v24, v172, v250, v252
    v_dot2_f32_bf16 v25, v172, v251, v252
    v_dot2_f32_bf16 v26, v173, v250, v252
    v_dot2_f32_bf16 v27, v173, v251, v252
    v_dot2_f32_bf16 v28, v174, v250, v252
    v_dot2_f32_bf16 v29, v174, v251, v252
    v_dot2_f32_bf16 v30, v175, v250, v252
    v_dot2_f32_bf16 v31, v175, v251, v252
    v_cvt_pk_bf16_f32 v168, v32, v33
    v_cvt_pk_bf16_f32 v169, v34, v35
    v_cvt_pk_bf16_f32 v170, v36, v37
    v_cvt_pk_bf16_f32 v171, v38, v39
    ds_write_b128 v231, v[168:171] offset:24960
    v_dot2_f32_bf16 v32, v176, v250, v252
    v_dot2_f32_bf16 v33, v176, v251, v252
    v_dot2_f32_bf16 v34, v177, v250, v252
    v_dot2_f32_bf16 v35, v177, v251, v252
    v_dot2_f32_bf16 v36, v178, v250, v252
    v_dot2_f32_bf16 v37, v178, v251, v252
    v_dot2_f32_bf16 v38, v179, v250, v252
    v_dot2_f32_bf16 v39, v179, v251, v252
    v_cvt_pk_bf16_f32 v172, v24, v25
    v_cvt_pk_bf16_f32 v173, v26, v27
    v_cvt_pk_bf16_f32 v174, v28, v29
    v_cvt_pk_bf16_f32 v175, v30, v31
    buffer_load_dwordx4 v5, s[32:35], s81 offen offset:2048  lds
    ds_write_b128 v231, v[172:175] offset:33280
    v_dot2_f32_bf16 v24, v180, v250, v252
    v_dot2_f32_bf16 v25, v180, v251, v252
    v_dot2_f32_bf16 v26, v181, v250, v252
    v_dot2_f32_bf16 v27, v181, v251, v252
    v_dot2_f32_bf16 v28, v182, v250, v252
    v_dot2_f32_bf16 v29, v182, v251, v252
    v_dot2_f32_bf16 v30, v183, v250, v252
    v_dot2_f32_bf16 v31, v183, v251, v252
    v_cvt_pk_bf16_f32 v176, v32, v33
    v_cvt_pk_bf16_f32 v177, v34, v35
    v_cvt_pk_bf16_f32 v178, v36, v37
    v_cvt_pk_bf16_f32 v179, v38, v39
    ds_write_b128 v231, v[176:179] offset:41600
    v_cvt_pk_bf16_f32 v180, v24, v25
    v_cvt_pk_bf16_f32 v181, v26, v27
    v_cvt_pk_bf16_f32 v182, v28, v29
    v_cvt_pk_bf16_f32 v183, v30, v31
    buffer_load_dwordx4 v6, s[32:35], s81 offen offset:3072  lds
    ds_write_b128 v231, v[180:183] offset:49920
    s_waitcnt lgkmcnt(0)
    s_barrier
    ds_read_b128 v[16:19], v9 offset:0
    ds_read_b128 v[20:23], v9 offset:2080
    ds_read_b128 v[24:27], v9 offset:4160
    ds_read_b128 v[28:31], v9 offset:6240
    ds_read_b128 v[32:35], v9 offset:8320
    ds_read_b128 v[36:39], v9 offset:10400
    ds_read_b128 v[40:43], v9 offset:12480
    s_add_u32 m0, s13, 57344
    s_add_u32 s81, s17, 4653056
    buffer_load_dwordx4 v2, s[60:63], s81 offen offset:0 sc1 lds
    ds_read_b128 v[44:47], v9 offset:14560
    ds_read_b128 v[48:51], v9 offset:16640
    ds_read_b128 v[52:55], v9 offset:18720
    ds_read_b128 v[56:59], v9 offset:20800
    ds_read_b128 v[60:63], v9 offset:22880
    ds_read_b128 v[64:67], v9 offset:24960
    ds_read_b128 v[68:71], v9 offset:27040
    buffer_load_dwordx4 v2, s[60:63], s81 offen offset:1024 sc1 lds
    ds_read_b128 v[72:75], v9 offset:29120
    ds_read_b128 v[76:79], v9 offset:31200
    ds_read_b128 v[80:83], v9 offset:33280
    ds_read_b128 v[84:87], v9 offset:35360
    ds_read_b128 v[88:91], v9 offset:37440
    ds_read_b128 v[92:95], v9 offset:39520
    ds_read_b128 v[96:99], v9 offset:41600
    buffer_load_dwordx4 v2, s[60:63], s81 offen offset:2048 sc1 lds
    ds_read_b128 v[100:103], v9 offset:43680
    ds_read_b128 v[104:107], v9 offset:45760
    ds_read_b128 v[108:111], v9 offset:47840
    ds_read_b128 v[112:115], v9 offset:49920
    ds_read_b128 v[116:119], v9 offset:52000
    ds_read_b128 v[120:123], v9 offset:54080
    ds_read_b128 v[124:127], v9 offset:56160
    buffer_load_dwordx4 v2, s[60:63], s81 offen offset:3072 sc1 lds
    buffer_store_dwordx4 a[236:239], v218, s[60:63], s7 offen sc1
    buffer_store_dwordx4 a[236:239], v218, s[60:63], s8 offen sc1
    buffer_store_dword a236, v14, s[60:63], s11 offen sc1
    s_waitcnt vmcnt(12) lgkmcnt(0)
    s_barrier
    ds_read_b64_tr_b16 v[192:193], v10 offset:0
    ds_read_b64_tr_b16 v[194:195], v10 offset:512
    ds_read_b64_tr_b16 v[196:197], v10 offset:2048
    ds_read_b64_tr_b16 v[198:199], v10 offset:2560
    ds_read_b64_tr_b16 v[200:201], v10 offset:4096
    ds_read_b64_tr_b16 v[202:203], v10 offset:4608
    ds_read_b64_tr_b16 v[204:205], v10 offset:6144
    ds_read_b64_tr_b16 v[206:207], v10 offset:6656
    s_waitcnt lgkmcnt(6)
    v_mfma_f32_32x32x16_bf16 v[128:143], v[192:195], v[16:19], 0
    s_waitcnt lgkmcnt(4)
    ds_read_b64_tr_b16 v[208:209], v10 offset:8192
    ds_read_b64_tr_b16 v[210:211], v10 offset:8704
    s_add_u32 m0, s13, 61440
    s_add_u32 s81, s17, 4657152
    v_mov_b32 v12, v218
    v_accvgpr_write_b32 a223, v229
    v_mfma_f32_32x32x16_bf16 v[128:143], v[196:199], v[20:23], v[128:143]
    s_waitcnt lgkmcnt(4)
    ds_read_b64_tr_b16 v[192:193], v10 offset:10240
    ds_read_b64_tr_b16 v[194:195], v10 offset:10752
    buffer_load_dwordx4 v2, s[60:63], s81 offen offset:0 sc1 lds
    s_add_u32 s78, s23, 131072
    v_add_u32 v9, s78, v2
    v_add_u32 v4, 57356, v2
    v_mfma_f32_32x32x16_bf16 v[128:143], v[200:203], v[24:27], v[128:143]
    s_waitcnt lgkmcnt(4)
    ds_read_b64_tr_b16 v[196:197], v10 offset:12288
    ds_read_b64_tr_b16 v[198:199], v10 offset:12800
    buffer_load_dwordx4 v2, s[60:63], s81 offen offset:1024 sc1 lds
    v_add_u32 v1, s13, v4
    v_add_u32 v4, s23, v4
    v_add_u32 v4, 40960, v4
    v_mfma_f32_32x32x16_bf16 v[128:143], v[204:207], v[28:31], v[128:143]
    s_waitcnt lgkmcnt(4)
    ds_read_b64_tr_b16 v[200:201], v10 offset:14336
    ds_read_b64_tr_b16 v[202:203], v10 offset:14848
    v_mov_b32 v5, v219
    v_bfe_u32 v248, v0, 5, 1
    v_lshlrev_b32 v248, 2, v248
    v_and_b32 v251, 31, v0
    v_mfma_f32_32x32x16_bf16 v[128:143], v[208:211], v[32:35], v[128:143]
    s_waitcnt lgkmcnt(4)
    ds_read_b64_tr_b16 v[204:205], v10 offset:16384
    ds_read_b64_tr_b16 v[206:207], v10 offset:16896
    v_sub_u32 v248, v251, v248
    v_mov_b32 v249, 0x3f80
    v_mov_b32 v250, 0x3f800000
    v_and_b32_e64 v251, 15, v0
    v_mfma_f32_32x32x16_bf16 v[128:143], v[192:195], v[36:39], v[128:143]
    s_waitcnt lgkmcnt(4)
    ds_read_b64_tr_b16 v[208:209], v10 offset:18432
    ds_read_b64_tr_b16 v[210:211], v10 offset:18944
    buffer_load_dwordx4 v2, s[60:63], s81 offen offset:2048 sc1 lds
    v_cmp_eq_u32 vcc, 0, v248
    v_cmp_eq_u32_e64 s[48:49], 1, v248
    v_cmp_eq_u32_e64 s[74:75], 2, v248
    v_mfma_f32_32x32x16_bf16 v[128:143], v[196:199], v[40:43], v[128:143]
    s_waitcnt lgkmcnt(4)
    ds_read_b64_tr_b16 v[192:193], v10 offset:20480
    ds_read_b64_tr_b16 v[194:195], v10 offset:20992
    v_cndmask_b32 v240, 0, v249, vcc
    v_cmp_eq_u32 vcc, 3, v248
    v_cndmask_b32_e64 v240, v240, v250, s[48:49]
    v_cndmask_b32_e64 v241, 0, v249, s[74:75]
    v_mfma_f32_32x32x16_bf16 v[128:143], v[200:203], v[44:47], v[128:143]
    s_waitcnt lgkmcnt(4)
    ds_read_b64_tr_b16 v[196:197], v10 offset:22528
    ds_read_b64_tr_b16 v[198:199], v10 offset:23040
    buffer_load_dwordx4 v2, s[60:63], s81 offen offset:3072 sc1 lds
    v_cndmask_b32 v241, v241, v250, vcc
    v_cmp_eq_u32 vcc, 8, v248
    v_cmp_eq_u32_e64 s[48:49], 9, v248
    v_mfma_f32_32x32x16_bf16 v[128:143], v[204:207], v[48:51], v[128:143]
    s_waitcnt lgkmcnt(4)
    ds_read_b64_tr_b16 v[200:201], v10 offset:24576
    ds_read_b64_tr_b16 v[202:203], v10 offset:25088
    v_cmp_eq_u32_e64 s[74:75], 10, v248
    v_cndmask_b32 v242, 0, v249, vcc
    v_cmp_eq_u32 vcc, 11, v248
    v_cndmask_b32_e64 v242, v242, v250, s[48:49]
    v_mfma_f32_32x32x16_bf16 v[128:143], v[208:211], v[52:55], v[128:143]
    s_waitcnt lgkmcnt(4)
    ds_read_b64_tr_b16 v[204:205], v10 offset:26624
    ds_read_b64_tr_b16 v[206:207], v10 offset:27136
    v_cndmask_b32_e64 v243, 0, v249, s[74:75]
    v_cndmask_b32 v243, v243, v250, vcc
    v_cmp_eq_u32 vcc, 16, v248
    v_cmp_eq_u32_e64 s[48:49], 17, v248
    v_mfma_f32_32x32x16_bf16 v[128:143], v[192:195], v[56:59], v[128:143]
    s_waitcnt lgkmcnt(4)
    ds_read_b64_tr_b16 v[208:209], v10 offset:28672
    ds_read_b64_tr_b16 v[210:211], v10 offset:29184
    s_add_u32 m0, s13, 65536
    s_add_u32 s81, s17, 4661248
    v_cmp_eq_u32_e64 s[74:75], 18, v248
    v_cndmask_b32 v244, 0, v249, vcc
    v_mfma_f32_32x32x16_bf16 v[128:143], v[196:199], v[60:63], v[128:143]
    s_waitcnt lgkmcnt(4)
    ds_read_b64_tr_b16 v[192:193], v10 offset:30720
    ds_read_b64_tr_b16 v[194:195], v10 offset:31232
    buffer_load_dwordx4 v2, s[60:63], s81 offen offset:0 sc1 lds
    v_cmp_eq_u32 vcc, 19, v248
    v_cndmask_b32_e64 v244, v244, v250, s[48:49]
    v_cndmask_b32_e64 v245, 0, v249, s[74:75]
    v_mfma_f32_32x32x16_bf16 v[128:143], v[200:203], v[64:67], v[128:143]
    s_waitcnt lgkmcnt(4)
    ds_read_b64_tr_b16 v[196:197], v10 offset:32768
    ds_read_b64_tr_b16 v[198:199], v10 offset:33280
    v_cndmask_b32 v245, v245, v250, vcc
    v_cmp_eq_u32 vcc, 24, v248
    v_cmp_eq_u32_e64 s[48:49], 25, v248
    v_cmp_eq_u32_e64 s[74:75], 26, v248
    v_mfma_f32_32x32x16_bf16 v[128:143], v[204:207], v[68:71], v[128:143]
    s_waitcnt lgkmcnt(4)
    ds_read_b64_tr_b16 v[200:201], v10 offset:34816
    ds_read_b64_tr_b16 v[202:203], v10 offset:35328
    buffer_load_dwordx4 v2, s[60:63], s81 offen offset:1024 sc1 lds
    v_cndmask_b32 v246, 0, v249, vcc
    v_cmp_eq_u32 vcc, 27, v248
    v_cndmask_b32_e64 v246, v246, v250, s[48:49]
    v_mfma_f32_32x32x16_bf16 v[128:143], v[208:211], v[72:75], v[128:143]
    s_waitcnt lgkmcnt(4)
    ds_read_b64_tr_b16 v[204:205], v10 offset:36864
    ds_read_b64_tr_b16 v[206:207], v10 offset:37376
    v_cndmask_b32_e64 v247, 0, v249, s[74:75]
    v_cndmask_b32 v247, v247, v250, vcc
    v_cmp_eq_u32 vcc, 0, v251
    v_cmp_eq_u32_e64 s[48:49], 1, v251
    v_mfma_f32_32x32x16_bf16 v[128:143], v[192:195], v[76:79], v[128:143]
    s_waitcnt lgkmcnt(4) vmcnt(13)
    s_barrier
    ds_read_b64_tr_b16 v[208:209], v10 offset:38912
    ds_read_b64_tr_b16 v[210:211], v10 offset:39424
    s_add_u32 m0, s23, 98304
    v_mfma_f32_32x32x16_bf16 v[128:143], v[196:199], v[80:83], v[128:143]
    s_waitcnt lgkmcnt(4)
    ds_read_b64_tr_b16 v[192:193], v10 offset:40960
    ds_read_b64_tr_b16 v[194:195], v10 offset:41472
    s_add_u32 s81, s18, 4694016
    v_cmp_eq_u32_e64 s[74:75], 2, v251
    v_cndmask_b32 v212, 0, v249, vcc
    v_cmp_eq_u32 vcc, 3, v251
    v_mfma_f32_32x32x16_bf16 v[128:143], v[200:203], v[84:87], v[128:143]
    s_waitcnt lgkmcnt(4)
    ds_read_b64_tr_b16 v[196:197], v10 offset:43008
    ds_read_b64_tr_b16 v[198:199], v10 offset:43520
    buffer_load_dwordx4 v2, s[60:63], s81 offen offset:0 sc1 lds
    v_cndmask_b32_e64 v212, v212, v250, s[48:49]
    v_cndmask_b32_e64 v213, 0, v249, s[74:75]
    v_cndmask_b32 v213, v213, v250, vcc
    v_mfma_f32_32x32x16_bf16 v[128:143], v[204:207], v[88:91], v[128:143]
    s_waitcnt lgkmcnt(4)
    ds_read_b64_tr_b16 v[200:201], v10 offset:45056
    ds_read_b64_tr_b16 v[202:203], v10 offset:45568
    buffer_load_dwordx4 v2, s[60:63], s81 offen offset:1024 sc1 lds
    v_cmp_eq_u32 vcc, 4, v251
    v_cmp_eq_u32_e64 s[48:49], 5, v251
    v_cmp_eq_u32_e64 s[74:75], 6, v251
    v_mfma_f32_32x32x16_bf16 v[128:143], v[208:211], v[92:95], v[128:143]
    s_waitcnt lgkmcnt(4)
    ds_read_b64_tr_b16 v[204:205], v10 offset:47104
    ds_read_b64_tr_b16 v[206:207], v10 offset:47616
    v_cndmask_b32 v214, 0, v249, vcc
    v_cmp_eq_u32 vcc, 63, v251
    v_cndmask_b32_e64 v214, v214, v250, s[48:49]
    v_cndmask_b32_e64 v215, 0, v249, s[74:75]
    v_mfma_f32_32x32x16_bf16 v[128:143], v[192:195], v[96:99], v[128:143]
    s_waitcnt lgkmcnt(4)
    ds_read_b64_tr_b16 v[208:209], v10 offset:49152
    ds_read_b64_tr_b16 v[210:211], v10 offset:49664
    buffer_load_dwordx4 v2, s[60:63], s81 offen offset:2048 sc1 lds
    v_cndmask_b32 v215, v215, v250, vcc
    s_mov_b32 s74, 0x88008800
    s_mov_b32 s75, 0x88008800
    v_mfma_f32_32x32x16_bf16 v[128:143], v[196:199], v[100:103], v[128:143]
    s_waitcnt lgkmcnt(4)
    ds_read_b64_tr_b16 v[192:193], v10 offset:51200
    ds_read_b64_tr_b16 v[194:195], v10 offset:51712
    ds_read_u16 v160, v230 offset:0
    ds_read_u16 v161, v230 offset:56
    v_mfma_f32_32x32x16_bf16 v[128:143], v[200:203], v[104:107], v[128:143]
    s_waitcnt lgkmcnt(6)
    ds_read_b64_tr_b16 v[196:197], v10 offset:53248
    ds_read_b64_tr_b16 v[198:199], v10 offset:53760
    ds_read_u16 v162, v230 offset:112
    ds_read_u16 v163, v230 offset:168
    v_mfma_f32_32x32x16_bf16 v[128:143], v[204:207], v[108:111], v[128:143]
    s_waitcnt lgkmcnt(8)
    ds_read_b64_tr_b16 v[200:201], v10 offset:55296
    ds_read_b64_tr_b16 v[202:203], v10 offset:55808
    buffer_load_dwordx4 v2, s[60:63], s81 offen offset:3072 sc1 lds
    ds_read_u16 v164, v230 offset:448
    ds_read_u16 v165, v230 offset:504
    v_mfma_f32_32x32x16_bf16 v[128:143], v[208:211], v[112:115], v[128:143]
    s_waitcnt lgkmcnt(10)
    ds_read_u16 v166, v230 offset:560
    ds_read_u16 v167, v230 offset:616
    ds_read_u16 v168, v230 offset:896
    ds_read_u16 v169, v230 offset:952
    v_mfma_f32_32x32x16_bf16 v[128:143], v[192:195], v[116:119], v[128:143]
    s_waitcnt lgkmcnt(10)
    ds_read_u16 v170, v230 offset:1008
    ds_read_u16 v171, v230 offset:1064
    ds_read_u16 v172, v230 offset:1344
    ds_read_u16 v173, v230 offset:1400
    v_mfma_f32_32x32x16_bf16 v[128:143], v[196:199], v[120:123], v[128:143]
    s_waitcnt lgkmcnt(10)
    ds_read_u16 v174, v230 offset:1456
    ds_read_u16 v175, v230 offset:1512
    s_add_u32 m0, s23, 114688
    s_add_u32 s81, s9, 0
    s_waitcnt lgkmcnt(0)
    v_lshl_or_b32 v232, v161, 16, v160
    v_mfma_f32_32x32x16_bf16 v[128:143], v[200:203], v[124:127], v[128:143]
    buffer_load_dwordx4 v224, s[28:31], s81 offen offset:0  lds
    v_lshl_or_b32 v233, v163, 16, v162
    v_lshl_or_b32 v234, v165, 16, v164
    v_lshl_or_b32 v235, v167, 16, v166
    v_lshl_or_b32 v236, v169, 16, v168
    v_lshl_or_b32 v237, v171, 16, v170
    buffer_load_dwordx4 v225, s[28:31], s81 offen offset:1024  lds
    v_lshl_or_b32 v238, v173, 16, v172
    v_lshl_or_b32 v239, v175, 16, v174
    v_cndmask_b32_e64 v238, v238, 0, s[72:73]
    v_cndmask_b32_e64 v239, v239, 0, s[72:73]
    v_xor_b32 v232, s4, v232
    v_xor_b32 v233, s4, v233
    v_xor_b32 v234, s4, v234
    v_xor_b32 v235, s4, v235
    v_xor_b32 v236, s4, v236
    v_xor_b32 v237, s4, v237
    v_xor_b32 v238, s4, v238
    v_xor_b32 v239, s4, v239
    v_cvt_pk_bf16_f32 v160, v128, v129
    v_cvt_pk_bf16_f32 v161, v130, v131
    v_cvt_pk_bf16_f32 v162, v132, v133
    v_cvt_pk_bf16_f32 v163, v134, v135
    v_cvt_pk_bf16_f32 v164, v136, v137
    v_cvt_pk_bf16_f32 v165, v138, v139
    v_cvt_pk_bf16_f32 v166, v140, v141
    v_cvt_pk_bf16_f32 v167, v142, v143
    v_mfma_f32_32x32x16_bf16 v[144:159], v[232:235], v[160:163], 0
    s_nop 0
    v_mfma_f32_32x32x16_bf16 v[144:159], v[236:239], v[164:167], v[144:159]
    s_lshl_b32 s88, s2, 1
    s_and_b32 s12, s3, 1
    s_add_u32 s88, s88, s12
    s_lshl_b32 s88, s88, 10
    s_add_u32 s12, s88, 0
    buffer_load_dwordx4 a[0:3], v2, s[44:47], s12 offen
    s_add_u32 s12, s88, 524288
    buffer_load_dwordx4 a[4:7], v2, s[44:47], s12 offen
    s_add_u32 s12, s88, 1048576
    buffer_load_dwordx4 a[8:11], v2, s[44:47], s12 offen
    s_nop 1
    s_nop 0
    v_max3_f32 v248, v144, v145, v146
    v_min3_f32 v249, v144, v145, v146
    v_max3_f32 v248, v248, v147, v148
    v_min3_f32 v249, v249, v147, v148
    v_max3_f32 v248, v248, v149, v150
    v_min3_f32 v249, v249, v149, v150
    v_max3_f32 v248, v248, v152, v153
    v_min3_f32 v249, v249, v152, v153
    v_max3_f32 v248, v248, v154, v155
    v_min3_f32 v249, v249, v154, v155
    v_max3_f32 v248, v248, v156, v157
    v_min3_f32 v249, v249, v156, v157
    v_max_f32 v248, v248, v158
    v_min_f32 v249, v249, v158
    v_mov_b32 v250, v248
    v_mov_b32 v251, v249
    s_nop 0
    v_permlane32_swap_b32 v248, v250
    v_permlane32_swap_b32 v249, v251
    v_max_f32 v248, v248, v250
    v_min_f32 v249, v249, v251
    v_mul_f32_e64 v248, -v248, s70
    v_mul_f32 v249, s70, v249
    v_pk_fma_f32 v[160:161], v[144:145], s[70:71], v[248:249] op_sel_hi:[1,0,0]
    v_pk_fma_f32 v[176:177], v[144:145], s[70:71], v[248:249] op_sel:[0,0,1] op_sel_hi:[1,0,1] neg_lo:[1,0,0] neg_hi:[1,0,0]
    v_exp_f32 v160, v160
    v_exp_f32 v176, v176
    v_exp_f32 v161, v161
    v_exp_f32 v177, v177
    v_pk_fma_f32 v[162:163], v[146:147], s[70:71], v[248:249] op_sel_hi:[1,0,0]
    v_pk_fma_f32 v[178:179], v[146:147], s[70:71], v[248:249] op_sel:[0,0,1] op_sel_hi:[1,0,1] neg_lo:[1,0,0] neg_hi:[1,0,0]
    v_exp_f32 v162, v162
    v_exp_f32 v178, v178
    v_exp_f32 v163, v163
    v_exp_f32 v179, v179
    v_pk_fma_f32 v[164:165], v[148:149], s[70:71], v[248:249] op_sel_hi:[1,0,0]
    v_pk_fma_f32 v[180:181], v[148:149], s[70:71], v[248:249] op_sel:[0,0,1] op_sel_hi:[1,0,1] neg_lo:[1,0,0] neg_hi:[1,0,0]
    v_exp_f32 v164, v164
    v_exp_f32 v180, v180
    v_exp_f32 v165, v165
    v_exp_f32 v181, v181
    v_pk_fma_f32 v[166:167], v[150:151], s[70:71], v[248:249] op_sel_hi:[1,0,0]
    v_pk_fma_f32 v[182:183], v[150:151], s[70:71], v[248:249] op_sel:[0,0,1] op_sel_hi:[1,0,1] neg_lo:[1,0,0] neg_hi:[1,0,0]
    v_exp_f32 v166, v166
    v_exp_f32 v182, v182
    v_pk_fma_f32 v[168:169], v[152:153], s[70:71], v[248:249] op_sel_hi:[1,0,0]
    v_pk_fma_f32 v[184:185], v[152:153], s[70:71], v[248:249] op_sel:[0,0,1] op_sel_hi:[1,0,1] neg_lo:[1,0,0] neg_hi:[1,0,0]
    v_exp_f32 v168, v168
    v_exp_f32 v184, v184
    v_exp_f32 v169, v169
    v_exp_f32 v185, v185
    v_pk_fma_f32 v[170:171], v[154:155], s[70:71], v[248:249] op_sel_hi:[1,0,0]
    v_pk_fma_f32 v[186:187], v[154:155], s[70:71], v[248:249] op_sel:[0,0,1] op_sel_hi:[1,0,1] neg_lo:[1,0,0] neg_hi:[1,0,0]
    v_exp_f32 v170, v170
    v_exp_f32 v186, v186
    v_exp_f32 v171, v171
    v_exp_f32 v187, v187
    v_pk_fma_f32 v[172:173], v[156:157], s[70:71], v[248:249] op_sel_hi:[1,0,0]
    v_pk_fma_f32 v[188:189], v[156:157], s[70:71], v[248:249] op_sel:[0,0,1] op_sel_hi:[1,0,1] neg_lo:[1,0,0] neg_hi:[1,0,0]
    v_exp_f32 v172, v172
    v_exp_f32_e64 v188, v188
    s_waitcnt vmcnt(5)
    ds_read2st64_b32 v[216:217], v1 offset0:0 offset1:4
    ds_read2st64_b32 v[218:219], v1 offset0:8 offset1:12
    ds_read2st64_b32 v[220:221], v1 offset0:16 offset1:20
    ds_read2st64_b32 v[222:223], v1 offset0:24 offset1:28
    ds_read2st64_b32 v[224:225], v1 offset0:32 offset1:36
    ds_read2st64_b32 v[226:227], v4 offset0:0 offset1:4
    ds_read2st64_b32 v[228:229], v4 offset0:8 offset1:12
    v_exp_f32 v173, v173
    v_exp_f32 v189, v189
    v_pk_fma_f32 v[174:175], v[158:159], s[70:71], v[248:249] op_sel_hi:[1,0,0]
    v_pk_fma_f32 v[190:191], v[158:159], s[70:71], v[248:249] op_sel:[0,0,1] op_sel_hi:[1,0,1] neg_lo:[1,0,0] neg_hi:[1,0,0]
    v_exp_f32 v174, v174
    v_exp_f32 v190, v190
    v_pk_add_f32 v[252:253], v[160:161], v[162:163]
    v_pk_add_f32 v[254:255], v[176:177], v[178:179]
    v_pk_add_f32 v[252:253], v[252:253], v[164:165]
    v_pk_add_f32 v[254:255], v[254:255], v[180:181]
    v_pk_add_f32 v[252:253], v[252:253], v[168:169]
    v_pk_add_f32 v[254:255], v[254:255], v[184:185]
    v_pk_add_f32 v[252:253], v[252:253], v[170:171]
    v_pk_add_f32 v[254:255], v[254:255], v[186:187]
    v_pk_add_f32 v[252:253], v[252:253], v[172:173]
    v_pk_add_f32 v[254:255], v[254:255], v[188:189]
    v_add_f32 v252, v252, v166
    v_add_f32 v254, v254, v182
    v_add_f32 v253, v253, v174
    v_add_f32 v255, v255, v190
    v_add_f32 v252, v252, v253
    v_add_f32 v254, v254, v255
    v_mov_b32 v250, v252
    v_mov_b32 v251, v254
    s_nop 0
    v_permlane32_swap_b32 v252, v250
    v_permlane32_swap_b32 v254, v251
    v_add_f32 v252, v252, v250
    v_add_f32 v254, v254, v251
    v_rcp_f32 v252, v252
    v_rcp_f32 v254, v254
    s_waitcnt lgkmcnt(0)
Lc_3:
    v_perm_b32 v216, v216, v217, s85
    v_perm_b32 v218, v218, v219, s85
    v_perm_b32 v220, v220, v221, s85
    v_perm_b32 v222, v222, v223, s85
    v_perm_b32 v224, v224, v225, s85
    v_perm_b32 v226, v226, v227, s85
    v_perm_b32 v228, v228, v229, s85
    v_max3_u32 v217, v216, v218, v220
    v_min3_u32 v219, v216, v218, v220
    v_max3_u32 v217, v217, v222, v224
    v_min3_u32 v219, v219, v222, v224
    v_max3_u32 v217, v217, v226, v228
    v_min3_u32 v219, v219, v226, v228
    v_cmp_ne_u32 vcc, s69, v217
    v_cmp_ne_u32_e64 s[48:49], s69, v219
    s_nop 0
    s_or_b64 vcc, vcc, s[48:49]
    s_cbranch_scc1 Lr_4
Lk_5:
    s_barrier
    s_nop 0
    ds_read_b64_tr_b16 v[192:193], v11 offset:0
    ds_read_b64_tr_b16 v[194:195], v11 offset:512
    ds_read_b64_tr_b16 v[196:197], v11 offset:2048
    ds_read_b64_tr_b16 v[198:199], v11 offset:2560
    ds_read_b64_tr_b16 v[200:201], v11 offset:4096
    ds_read_b64_tr_b16 v[202:203], v11 offset:4608
    ds_read_b64_tr_b16 v[204:205], v11 offset:6144
    ds_read_b64_tr_b16 v[206:207], v11 offset:6656
    s_waitcnt lgkmcnt(6)
    v_mfma_f32_32x32x16_bf16 v[216:231], v[16:19], v[192:195], 0
    s_waitcnt lgkmcnt(4)
    ds_read_b64_tr_b16 v[208:209], v11 offset:8192
    ds_read_b64_tr_b16 v[210:211], v11 offset:8704
    v_mul_f32 v176, v176, v254
    v_mul_f32 v177, v177, v254
    v_cvt_pk_bf16_f32 v136, v176, v177
    v_mul_f32 v178, v178, v254
    v_mfma_f32_32x32x16_bf16 v[216:231], v[20:23], v[196:199], v[216:231]
    s_waitcnt lgkmcnt(4)
    ds_read_b64_tr_b16 v[192:193], v11 offset:10240
    ds_read_b64_tr_b16 v[194:195], v11 offset:10752
    v_mul_f32 v179, v179, v254
    v_cvt_pk_bf16_f32 v137, v178, v179
    v_mul_f32 v180, v180, v254
    v_mul_f32 v181, v181, v254
    v_mfma_f32_32x32x16_bf16 v[216:231], v[24:27], v[200:203], v[216:231]
    s_waitcnt lgkmcnt(4)
    ds_read_b64_tr_b16 v[196:197], v11 offset:12288
    ds_read_b64_tr_b16 v[198:199], v11 offset:12800
    v_cvt_pk_bf16_f32 v138, v180, v181
    v_mul_f32 v182, v254, v182
    v_cvt_pk_bf16_f32 v139, v182, 0
    v_mul_f32 v184, v184, v254
    v_mfma_f32_32x32x16_bf16 v[216:231], v[28:31], v[204:207], v[216:231]
    s_waitcnt lgkmcnt(4)
    ds_read_b64_tr_b16 v[200:201], v11 offset:14336
    ds_read_b64_tr_b16 v[202:203], v11 offset:14848
    v_mul_f32 v185, v185, v254
    v_cvt_pk_bf16_f32 v140, v184, v185
    v_mul_f32 v186, v186, v254
    v_mul_f32 v187, v187, v254
    v_mfma_f32_32x32x16_bf16 v[216:231], v[32:35], v[208:211], v[216:231]
    s_waitcnt lgkmcnt(4)
    ds_read_b64_tr_b16 v[204:205], v11 offset:16384
    ds_read_b64_tr_b16 v[206:207], v11 offset:16896
    v_cvt_pk_bf16_f32 v141, v186, v187
    v_mul_f32 v188, v188, v254
    v_mul_f32 v189, v189, v254
    v_cvt_pk_bf16_f32 v142, v188, v189
    v_mfma_f32_32x32x16_bf16 v[216:231], v[36:39], v[192:195], v[216:231]
    s_waitcnt lgkmcnt(4)
    ds_read_b64_tr_b16 v[208:209], v11 offset:18432
    ds_read_b64_tr_b16 v[210:211], v11 offset:18944
    v_mul_f32 v190, v254, v190
    v_cvt_pk_bf16_f32 v143, v190, 0
    v_mfma_f32_32x32x16_bf16 v[144:159], v[136:139], v[240:243], 0
    s_nop 0
    v_mfma_f32_32x32x16_bf16 v[144:159], v[140:143], v[244:247], v[144:159]
    v_mul_f32 v160, v160, v252
    v_mul_f32 v161, v161, v252
    v_cvt_pk_bf16_f32 v128, v160, v161
    v_mul_f32 v162, v162, v252
    v_mul_f32 v163, v163, v252
    v_cvt_pk_bf16_f32 v129, v162, v163
    v_mfma_f32_32x32x16_bf16 v[216:231], v[40:43], v[196:199], v[216:231]
    s_waitcnt lgkmcnt(4)
    ds_read_b64_tr_b16 v[192:193], v11 offset:20480
    ds_read_b64_tr_b16 v[194:195], v11 offset:20992
    v_mul_f32 v164, v164, v252
    v_mul_f32 v165, v165, v252
    v_cvt_pk_bf16_f32 v130, v164, v165
    v_mul_f32 v166, v252, v166
    v_mfma_f32_32x32x16_bf16 v[216:231], v[44:47], v[200:203], v[216:231]
    s_waitcnt lgkmcnt(4)
    ds_read_b64_tr_b16 v[196:197], v11 offset:22528
    ds_read_b64_tr_b16 v[198:199], v11 offset:23040
    v_cvt_pk_bf16_f32 v131, v166, 0
    v_mul_f32 v168, v168, v252
    v_mul_f32 v169, v169, v252
    v_cvt_pk_bf16_f32 v132, v168, v169
    v_mfma_f32_32x32x16_bf16 v[216:231], v[48:51], v[204:207], v[216:231]
    s_waitcnt lgkmcnt(4)
    ds_read_b64_tr_b16 v[200:201], v11 offset:24576
    ds_read_b64_tr_b16 v[202:203], v11 offset:25088
    v_mul_f32 v170, v170, v252
    v_mul_f32 v171, v171, v252
    v_cvt_pk_bf16_f32 v133, v170, v171
    v_mul_f32 v172, v172, v252
    v_mfma_f32_32x32x16_bf16 v[216:231], v[52:55], v[208:211], v[216:231]
    s_waitcnt lgkmcnt(4)
    ds_read_b64_tr_b16 v[204:205], v11 offset:26624
    ds_read_b64_tr_b16 v[206:207], v11 offset:27136
    v_mul_f32 v173, v173, v252
    v_cvt_pk_bf16_f32 v134, v172, v173
    v_mul_f32_e64 v174, v252, v174
    v_cvt_pk_bf16_f32 v135, v174, 0
    v_mfma_f32_32x32x16_bf16 v[176:191], v[128:131], v[240:243], 0
    s_nop 0
    v_mfma_f32_32x32x16_bf16 v[176:191], v[132:135], v[244:247], v[176:191]
    v_cvt_pk_bf16_f32 v160, v144, v145
    v_cvt_pk_bf16_f32 v161, v146, v147
    v_cvt_pk_bf16_f32 v162, v148, v149
    v_cvt_pk_bf16_f32 v163, v150, v151
    v_cvt_pk_bf16_f32 v164, v152, v153
    v_cvt_pk_bf16_f32 v165, v154, v155
    v_mfma_f32_32x32x16_bf16 v[216:231], v[56:59], v[192:195], v[216:231]
    s_waitcnt lgkmcnt(4)
    ds_read_b64_tr_b16 v[208:209], v11 offset:28672
    ds_read_b64_tr_b16 v[210:211], v11 offset:29184
    v_cvt_pk_bf16_f32 v166, v156, v157
    v_cvt_pk_bf16_f32 v167, v158, v159
    v_mfma_f32_32x32x16_bf16 v[216:231], v[60:63], v[196:199], v[216:231]
    s_waitcnt lgkmcnt(4)
    ds_read_b64_tr_b16 v[192:193], v11 offset:30720
    ds_read_b64_tr_b16 v[194:195], v11 offset:31232
    ds_write_b128 v9, v[160:163]
    v_mfma_f32_32x32x16_bf16 v[216:231], v[64:67], v[200:203], v[216:231]
    s_waitcnt lgkmcnt(5)
    ds_read_b64_tr_b16 v[196:197], v11 offset:32768
    ds_read_b64_tr_b16 v[198:199], v11 offset:33280
    ds_write_b128 v9, v[164:167] offset:1024
    v_mfma_f32_32x32x16_bf16 v[216:231], v[68:71], v[204:207], v[216:231]
    s_waitcnt lgkmcnt(6)
    ds_read_b64_tr_b16 v[200:201], v11 offset:34816
    ds_read_b64_tr_b16 v[202:203], v11 offset:35328
    v_cvt_pk_bf16_f32 v168, v176, v177
    v_cvt_pk_bf16_f32 v169, v178, v179
    v_cvt_pk_bf16_f32 v170, v180, v181
    v_cvt_pk_bf16_f32 v171, v182, v183
    v_mfma_f32_32x32x16_bf16 v[216:231], v[72:75], v[208:211], v[216:231]
    s_waitcnt lgkmcnt(6)
    ds_read_b64_tr_b16 v[204:205], v11 offset:36864
    ds_read_b64_tr_b16 v[206:207], v11 offset:37376
    s_add_u32 m0, s13, 0
    s_add_u32 s81, s17, 4194304
    v_cvt_pk_bf16_f32 v172, v184, v185
    v_cvt_pk_bf16_f32 v173, v186, v187
    v_mfma_f32_32x32x16_bf16 v[216:231], v[76:79], v[192:195], v[216:231]
    s_waitcnt lgkmcnt(5)
    ds_read_b64_tr_b16 v[208:209], v11 offset:38912
    ds_read_b64_tr_b16 v[210:211], v11 offset:39424
    buffer_load_dwordx4 v2, s[60:63], s81 offen offset:0 sc1 lds
    v_cvt_pk_bf16_f32 v174, v188, v189
    v_cvt_pk_bf16_f32 v175, v190, v191
    v_mov_b32 v249, 0x3f803f80
    v_mfma_f32_32x32x16_bf16 v[216:231], v[80:83], v[196:199], v[216:231]
    s_waitcnt lgkmcnt(4)
    ds_read_b64_tr_b16 v[192:193], v11 offset:40960
    ds_read_b64_tr_b16 v[194:195], v11 offset:41472
    buffer_load_dwordx4 v2, s[60:63], s81 offen offset:1024 sc1 lds
    v_xor_b32 v248, 0x2000, v9
    s_lshl_b32 s77, s20, 5
    v_mfma_f32_32x32x16_bf16 v[216:231], v[84:87], v[200:203], v[216:231]
    s_waitcnt lgkmcnt(4)
    ds_read_b64_tr_b16 v[196:197], v11 offset:43008
    ds_read_b64_tr_b16 v[198:199], v11 offset:43520
    v_mfma_f32_32x32x16_bf16 v[216:231], v[88:91], v[204:207], v[216:231]
    s_waitcnt lgkmcnt(4)
    ds_read_b64_tr_b16 v[200:201], v11 offset:45056
    ds_read_b64_tr_b16 v[202:203], v11 offset:45568
    buffer_load_dwordx4 v2, s[60:63], s81 offen offset:2048 sc1 lds
    v_mfma_f32_32x32x16_bf16 v[216:231], v[92:95], v[208:211], v[216:231]
    s_waitcnt lgkmcnt(4)
    ds_read_b64_tr_b16 v[204:205], v11 offset:47104
    ds_read_b64_tr_b16 v[206:207], v11 offset:47616
    v_mfma_f32_32x32x16_bf16 v[216:231], v[96:99], v[192:195], v[216:231]
    s_waitcnt lgkmcnt(4)
    ds_read_b64_tr_b16 v[208:209], v11 offset:49152
    ds_read_b64_tr_b16 v[210:211], v11 offset:49664
    buffer_load_dwordx4 v2, s[60:63], s81 offen offset:3072 sc1 lds
    v_mfma_f32_32x32x16_bf16 v[216:231], v[100:103], v[196:199], v[216:231]
    s_waitcnt lgkmcnt(4)
    ds_read_b64_tr_b16 v[192:193], v11 offset:51200
    ds_read_b64_tr_b16 v[194:195], v11 offset:51712
    v_mfma_f32_32x32x16_bf16 v[216:231], v[104:107], v[200:203], v[216:231]
    s_waitcnt lgkmcnt(4)
    ds_read_b64_tr_b16 v[196:197], v11 offset:53248
    ds_read_b64_tr_b16 v[198:199], v11 offset:53760
    v_mfma_f32_32x32x16_bf16 v[216:231], v[108:111], v[204:207], v[216:231]
    s_waitcnt lgkmcnt(4)
    ds_read_b64_tr_b16 v[200:201], v11 offset:55296
    ds_read_b64_tr_b16 v[202:203], v11 offset:55808
    s_add_u32 m0, s13, 4096
    s_add_u32 s81, s17, 4198400
    v_mfma_f32_32x32x16_bf16 v[216:231], v[112:115], v[208:211], v[216:231]
    s_waitcnt lgkmcnt(4)
    buffer_load_dwordx4 v2, s[60:63], s81 offen offset:0 sc1 lds
    v_mfma_f32_32x32x16_bf16 v[216:231], v[116:119], v[192:195], v[216:231]
    s_waitcnt lgkmcnt(2)
    buffer_load_dwordx4 v2, s[60:63], s81 offen offset:1024 sc1 lds
    v_mfma_f32_32x32x16_bf16 v[216:231], v[120:123], v[196:199], v[216:231]
    s_waitcnt lgkmcnt(0)
    v_mfma_f32_32x32x16_bf16 v[216:231], v[124:127], v[200:203], v[216:231]
    s_nop 11
    v_cvt_pk_bf16_f32 v192, v216, v217
    v_cndmask_b32_e64 v192, v192, v249, s[74:75]
    v_cvt_pk_bf16_f32 v193, v218, v219
    v_cndmask_b32_e64 v193, v193, v249, s[74:75]
    v_cvt_pk_bf16_f32 v194, v220, v221
    v_cndmask_b32_e64 v194, v194, v249, s[74:75]
    v_cvt_pk_bf16_f32 v195, v222, v223
    v_cndmask_b32_e64 v195, v195, v249, s[74:75]
    ds_write_b128 v9, v[192:195] offset:2048
    v_cvt_pk_bf16_f32 v196, v224, v225
    v_cndmask_b32_e64 v196, v196, v249, s[74:75]
    v_cvt_pk_bf16_f32 v197, v226, v227
    v_cndmask_b32_e64 v197, v197, v249, s[74:75]
    v_cvt_pk_bf16_f32 v198, v228, v229
    v_cndmask_b32_e64 v198, v198, v249, s[74:75]
    v_cvt_pk_bf16_f32 v199, v230, v231
    v_cndmask_b32_e64 v199, v199, v249, s[74:75]
    ds_write_b128 v9, v[196:199] offset:3072
    v_mfma_f32_32x32x16_bf16 v[144:159], v[168:171], v[192:195], 0
    s_waitcnt lgkmcnt(0)
    s_barrier
    ds_read_b128 v[160:163], v248
    ds_read_b128 v[164:167], v248 offset:1024
    ds_read_b128 v[200:203], v248 offset:2048
    ds_read_b128 v[204:207], v248 offset:3072
    v_mfma_f32_32x32x16_bf16 v[144:159], v[172:175], v[196:199], v[144:159]
    buffer_load_dwordx4 v2, s[60:63], s81 offen offset:2048 sc1 lds
    buffer_load_dwordx4 v2, s[60:63], s81 offen offset:3072 sc1 lds
    s_waitcnt lgkmcnt(1)
    v_mfma_f32_32x32x16_bf16 v[144:159], v[160:163], v[200:203], v[144:159]
    s_waitcnt lgkmcnt(0)
    v_mfma_f32_32x32x16_bf16 v[144:159], v[164:167], v[204:207], v[144:159]
    v_bfe_u32 v241, v0, 4, 1
    v_lshlrev_b32 v241, 6, v241
    v_and_b32 v242, 0x70, v2
    v_xor_b32 v241, v241, v242
    v_xor_b32 v241, s77, v241
    v_lshrrev_b32 v240, 3, v0
    v_mul_u32_u24 v240, 3584, v240
    v_add_u32 v240, v240, v241
    v_or_b32 v240, s25, v240
    v_add_u32 v241, 27648, v240
    v_add_u32 v242, 55296, v240
    v_add_u32 v243, 82944, v240
    v_cvt_pk_bf16_f32 v128, v144, v145
    v_cvt_pk_bf16_f32 v129, v146, v147
    v_cvt_pk_bf16_f32 v130, v148, v149
    v_cvt_pk_bf16_f32 v131, v150, s86
    buffer_store_dwordx4 v[128:131], v12, s[60:63], s7 offen sc1
    v_cvt_pk_bf16_f32 v132, v152, v153
    v_cvt_pk_bf16_f32 v133, v154, v155
    v_cvt_pk_bf16_f32 v134, v156, v157
    v_cvt_pk_bf16_f32 v135, v158, s86
    buffer_store_dwordx4 v[132:135], v12, s[60:63], s8 offen sc1
    s_waitcnt vmcnt(13)
    s_nop 0
    ds_read_b64 a[224:225], v5 offset:0
    ds_read_b64 a[226:227], v5 offset:16
    ds_read_b64 a[228:229], v5 offset:32
    ds_read_b64 a[230:231], v5 offset:48
    s_add_u32 m0, s13, 8192
    s_add_u32 s81, s17, 4202496
    buffer_load_dwordx4 v2, s[60:63], s81 offen offset:0 sc1 lds
    buffer_load_dwordx4 v2, s[60:63], s81 offen offset:1024 sc1 lds
    s_add_u32 m0, s23, 40960
    s_add_u32 s81, s18, 4235264
    buffer_load_dwordx4 v2, s[60:63], s81 offen offset:0 sc1 lds
    buffer_load_dwordx4 v2, s[60:63], s81 offen offset:1024 sc1 lds
    buffer_load_dwordx4 v2, s[60:63], s81 offen offset:2048 sc1 lds
    buffer_load_dwordx4 v2, s[60:63], s81 offen offset:3072 sc1 lds
    buffer_store_dwordx4 a[236:239], v2, s[60:63], s50 offen sc1
    buffer_store_dwordx4 a[236:239], v2, s[60:63], s50 offen offset:1024 sc1
La_1:
    s_mov_b64 exec, 0xffff
    buffer_store_dwordx4 a[236:239], v2, s[60:63], s15 offen sc1
    s_mov_b64 exec, -1
Lb_2:
    s_nop 0
    v_accvgpr_read_b32 v12, a223
    ds_read_u16 v160, v12 offset:0
    ds_read_u16 v161, v12 offset:56
    ds_read_u16 v162, v12 offset:112
    ds_read_u16 v163, v12 offset:168
    ds_read_u16 v164, v12 offset:224
    ds_read_u16 v165, v12 offset:280
    ds_read_u16 v166, v12 offset:336
    ds_read_u16 v168, v12 offset:784
    ds_read_u16 v169, v12 offset:840
    ds_read_u16 v170, v12 offset:896
    ds_read_u16 v171, v12 offset:952
    ds_read_u16 v172, v12 offset:1008
    ds_read_u16 v173, v12 offset:1064
    ds_read_u16 v174, v12 offset:1120
    v_subrev_u32 v11, 57344, v11
    v_subrev_u32 v1, 57344, v1
    v_subrev_u32 v4, 57344, v4
    s_mul_i32 s76, s3, 100352
    s_lshl_b32 s77, s27, 7
    s_add_u32 s76, s76, s77
    s_lshl_b32 s16, s3, 14
    s_and_b32 s21, s3, 1
    v_mov_b32 v9, 2146435072
    v_cmp_gt_u32 vcc, 4, v0
    s_nop 1
    v_cndmask_b32 v9, v9, v2, vcc
    s_waitcnt lgkmcnt(0)
    v_lshl_or_b32 v232, v161, 16, v160
    v_lshl_or_b32 v233, v163, 16, v162
    v_lshl_or_b32 v234, v165, 16, v164
    v_mov_b32 v235, v166
    v_lshl_or_b32 v236, v169, 16, v168
    v_lshl_or_b32 v237, v171, 16, v170
    v_lshl_or_b32 v238, v173, 16, v172
    v_mov_b32 v239, v174
    s_mov_b64 exec, 0
    s_cmp_eq_u32 s3, 0
    s_cbranch_scc1 L_pb0
    s_cmp_eq_u32 s3, 1
    s_cbranch_scc1 L_pb1
    s_cmp_eq_u32 s3, 2
    s_cbranch_scc1 L_pb2
    s_cmp_eq_u32 s3, 3
    s_cbranch_scc1 L_pb3
    s_branch L_page
L_spare:
    s_load_dwordx4 s[4:7], s[0:1], 40
    s_sub_u32 s76, s2, 224
    s_lshr_b32 s77, s76, 1
    s_and_b32 s78, s76, 1
    v_lshrrev_b32 v9, 4, v0
    v_mul_u32_u24 v9, 3584, v9
    v_and_b32 v10, 0xf0, v2
    v_add_u32 v9, v9, v10
    s_lshl_b32 s79, s77, 8
    s_mul_i32 s80, s3, 401408
    s_add_u32 s79, s79, s80
    s_cmp_lt_u32 s76, 28
    s_cselect_b32 s82, 0, 2146435072
    s_add_u32 s79, s79, s82
    s_waitcnt lgkmcnt(0)
    s_cmp_eq_u32 s78, 0
    s_cselect_b32 s44, s4, s6
    s_cselect_b32 s45, s5, s7
    buffer_load_dwordx4 v[16:19], v9, s[44:47], s79 offen
    s_add_u32 s79, s79, 14336
    buffer_load_dwordx4 v[20:23], v9, s[44:47], s79 offen
    s_add_u32 s79, s79, 14336
    buffer_load_dwordx4 v[24:27], v9, s[44:47], s79 offen
    s_add_u32 s79, s79, 14336
    buffer_load_dwordx4 v[28:31], v9, s[44:47], s79 offen
    s_add_u32 s79, s79, 14336
    buffer_load_dwordx4 v[32:35], v9, s[44:47], s79 offen
    s_add_u32 s79, s79, 14336
    buffer_load_dwordx4 v[36:39], v9, s[44:47], s79 offen
    s_add_u32 s79, s79, 14336
    buffer_load_dwordx4 v[40:43], v9, s[44:47], s79 offen
    s_add_u32 s79, s79, 14336
    buffer_load_dwordx4 v[44:47], v9, s[44:47], s79 offen
    s_add_u32 s79, s79, 14336
    buffer_load_dwordx4 v[48:51], v9, s[44:47], s79 offen
    s_add_u32 s79, s79, 14336
    buffer_load_dwordx4 v[52:55], v9, s[44:47], s79 offen
    s_add_u32 s79, s79, 14336
    buffer_load_dwordx4 v[56:59], v9, s[44:47], s79 offen
    s_add_u32 s79, s79, 14336
    buffer_load_dwordx4 v[60:63], v9, s[44:47], s79 offen
    s_add_u32 s79, s79, 14336
    buffer_load_dwordx4 v[64:67], v9, s[44:47], s79 offen
    s_add_u32 s79, s79, 14336
    buffer_load_dwordx4 v[68:71], v9, s[44:47], s79 offen
    s_add_u32 s79, s79, 14336
    buffer_load_dwordx4 v[72:75], v9, s[44:47], s79 offen
    s_add_u32 s79, s79, 14336
    buffer_load_dwordx4 v[76:79], v9, s[44:47], s79 offen
    s_add_u32 s79, s79, 14336
    buffer_load_dwordx4 v[80:83], v9, s[44:47], s79 offen
    s_add_u32 s79, s79, 14336
    buffer_load_dwordx4 v[84:87], v9, s[44:47], s79 offen
    s_add_u32 s79, s79, 14336
    buffer_load_dwordx4 v[88:91], v9, s[44:47], s79 offen
    s_add_u32 s79, s79, 14336
    buffer_load_dwordx4 v[92:95], v9, s[44:47], s79 offen
    s_add_u32 s79, s79, 14336
    buffer_load_dwordx4 v[96:99], v9, s[44:47], s79 offen
    s_add_u32 s79, s79, 14336
    buffer_load_dwordx4 v[100:103], v9, s[44:47], s79 offen
    s_add_u32 s79, s79, 14336
    buffer_load_dwordx4 v[104:107], v9, s[44:47], s79 offen
    s_add_u32 s79, s79, 14336
    buffer_load_dwordx4 v[108:111], v9, s[44:47], s79 offen
    s_add_u32 s79, s79, 14336
    buffer_load_dwordx4 v[112:115], v9, s[44:47], s79 offen
    s_add_u32 s79, s79, 14336
    buffer_load_dwordx4 v[116:119], v9, s[44:47], s79 offen
    s_add_u32 s79, s79, 14336
    buffer_load_dwordx4 v[120:123], v9, s[44:47], s79 offen
    s_add_u32 s79, s79, 14336
    buffer_load_dwordx4 v[124:127], v9, s[44:47], s79 offen
    s_add_u32 s79, s79, 14336
    v_mov_b32 v128, 0x3f800000
    v_and_b32 v129, 15, v0
    v_cmp_eq_u32 vcc, 7, v129
    s_nop 1
    v_cndmask_b32 v215, v215, v128, vcc
    s_waitcnt vmcnt(27)
    s_nop 0
    v_mfma_f32_16x16x32_bf16 v[244:247], v[212:215], v[16:19], 0
    s_waitcnt vmcnt(26)
    v_mfma_f32_16x16x32_bf16 v[244:247], v[212:215], v[20:23], v[244:247]
    s_waitcnt vmcnt(25)
    v_mfma_f32_16x16x32_bf16 v[244:247], v[212:215], v[24:27], v[244:247]
    s_waitcnt vmcnt(24)
    v_mfma_f32_16x16x32_bf16 v[244:247], v[212:215], v[28:31], v[244:247]
    s_waitcnt vmcnt(23)
    v_mfma_f32_16x16x32_bf16 v[244:247], v[212:215], v[32:35], v[244:247]
    s_waitcnt vmcnt(22)
    v_mfma_f32_16x16x32_bf16 v[244:247], v[212:215], v[36:39], v[244:247]
    s_waitcnt vmcnt(21)
    v_mfma_f32_16x16x32_bf16 v[244:247], v[212:215], v[40:43], v[244:247]
    s_waitcnt vmcnt(20)
    v_mfma_f32_16x16x32_bf16 v[244:247], v[212:215], v[44:47], v[244:247]
    s_waitcnt vmcnt(19)
    v_mfma_f32_16x16x32_bf16 v[244:247], v[212:215], v[48:51], v[244:247]
    s_waitcnt vmcnt(18)
    v_mfma_f32_16x16x32_bf16 v[244:247], v[212:215], v[52:55], v[244:247]
    s_waitcnt vmcnt(17)
    v_mfma_f32_16x16x32_bf16 v[244:247], v[212:215], v[56:59], v[244:247]
    s_waitcnt vmcnt(16)
    v_mfma_f32_16x16x32_bf16 v[244:247], v[212:215], v[60:63], v[244:247]
    s_waitcnt vmcnt(15)
    v_mfma_f32_16x16x32_bf16 v[244:247], v[212:215], v[64:67], v[244:247]
    s_waitcnt vmcnt(14)
    v_mfma_f32_16x16x32_bf16 v[244:247], v[212:215], v[68:71], v[244:247]
    s_waitcnt vmcnt(13)
    v_mfma_f32_16x16x32_bf16 v[244:247], v[212:215], v[72:75], v[244:247]
    s_waitcnt vmcnt(12)
    v_mfma_f32_16x16x32_bf16 v[244:247], v[212:215], v[76:79], v[244:247]
    s_waitcnt vmcnt(11)
    v_mfma_f32_16x16x32_bf16 v[244:247], v[212:215], v[80:83], v[244:247]
    s_waitcnt vmcnt(10)
    v_mfma_f32_16x16x32_bf16 v[244:247], v[212:215], v[84:87], v[244:247]
    s_waitcnt vmcnt(9)
    v_mfma_f32_16x16x32_bf16 v[244:247], v[212:215], v[88:91], v[244:247]
    s_waitcnt vmcnt(8)
    v_mfma_f32_16x16x32_bf16 v[244:247], v[212:215], v[92:95], v[244:247]
    s_waitcnt vmcnt(7)
    v_mfma_f32_16x16x32_bf16 v[244:247], v[212:215], v[96:99], v[244:247]
    s_waitcnt vmcnt(6)
    v_mfma_f32_16x16x32_bf16 v[244:247], v[212:215], v[100:103], v[244:247]
    s_waitcnt vmcnt(5)
    v_mfma_f32_16x16x32_bf16 v[244:247], v[212:215], v[104:107], v[244:247]
    s_waitcnt vmcnt(4)
    v_mfma_f32_16x16x32_bf16 v[244:247], v[212:215], v[108:111], v[244:247]
    s_waitcnt vmcnt(3)
    v_mfma_f32_16x16x32_bf16 v[244:247], v[212:215], v[112:115], v[244:247]
    s_waitcnt vmcnt(2)
    v_mfma_f32_16x16x32_bf16 v[244:247], v[212:215], v[116:119], v[244:247]
    s_waitcnt vmcnt(1)
    v_mfma_f32_16x16x32_bf16 v[244:247], v[212:215], v[120:123], v[244:247]
    s_waitcnt vmcnt(0)
    v_mfma_f32_16x16x32_bf16 v[244:247], v[212:215], v[124:127], v[244:247]
    s_lshl_b32 s80, s3, 10
    v_add_u32 v10, s80, v2
    v_bfe_u32 v11, v0, 1, 4
    v_and_b32 v12, 1, v0
    v_lshl_add_u32 v11, v12, 4, v11
    v_lshlrev_b32 v12, 4, v11
    s_barrier
    s_nop 0
    ds_write_b128 v10, v[244:247]
    s_waitcnt lgkmcnt(0)
    s_barrier
    ds_read_b128 v[16:19], v12 offset:0
    ds_read_b128 v[20:23], v12 offset:1024
    ds_read_b128 v[24:27], v12 offset:2048
    ds_read_b128 v[28:31], v12 offset:3072
    v_mov_b32 v11, 2146435072
    v_cndmask_b32_e64 v10, v2, v11, s[72:73]
    s_mul_i32 s79, s78, 7168
    s_lshl_b32 s80, s77, 9
    s_add_u32 s79, s79, s80
    s_add_u32 s79, s79, 720896
    s_cmp_eq_u32 s3, 0
    s_cselect_b32 s82, s82, 0x10000000
    s_min_u32 s82, s82, 0x10000000
    s_add_u32 s79, s79, s82
    s_lshl_b32 s80, s76, 6
    s_add_u32 s80, s80, 753664
    s_add_u32 s80, s80, s82
    s_waitcnt lgkmcnt(0)
    s_nop 0
    v_pk_add_f32 v[16:17], v[16:17], v[20:21]
    v_pk_add_f32 v[18:19], v[18:19], v[22:23]
    v_pk_add_f32 v[16:17], v[16:17], v[24:25]
    v_pk_add_f32 v[18:19], v[18:19], v[26:27]
    v_pk_add_f32 v[16:17], v[16:17], v[28:29]
    v_pk_add_f32 v[18:19], v[18:19], v[30:31]
    buffer_store_dwordx4 v[16:19], v10, s[60:63], s79 offen sc1
    s_lshl_b32 s81, s76, 2
    s_add_u32 s81, s81, s3
    s_mul_i32 s81, s81, 12544
    s_waitcnt vmcnt(0)
    buffer_store_dword v15, v14, s[60:63], s80 offen sc1
    s_lshl_b32 s20, s76, 2
    s_add_u32 s20, s20, s3
    s_lshr_b32 s24, s20, 3
    s_mul_i32 s24, s24, 114688
    s_mul_i32 s21, s20, 43008
    s_add_u32 s21, s21, s24
    s_add_u32 s21, s21, 10600448
    v_mov_b32 v136, -1
    v_mov_b32 v137, -1
    v_mov_b32 v138, -1
    v_mov_b32 v139, -1
    s_mov_b32 s24, 14
L_sp2:
    buffer_store_dwordx4 v[136:139], v2, s[60:63], s21 offen sc1
    buffer_store_dwordx4 v[136:139], v2, s[60:63], s21 offen offset:1024 sc1
    buffer_store_dwordx4 v[136:139], v2, s[60:63], s21 offen offset:2048 sc1
    s_add_u32 s21, s21, 3072
    s_sub_u32 s24, s24, 1
    s_waitcnt vmcnt(8)
    s_cmp_lg_u32 s24, 0
    s_cbranch_scc1 L_sp2
    s_lshl_b32 s20, s20, 6
    s_add_u32 s20, s20, 770048
    s_waitcnt vmcnt(0)
    buffer_store_dword v15, v14, s[60:63], s20 offen sc1
    s_branch L_fin
    .p2align 12
L_page:
L_wr_r:
    s_mov_b64 exec, -1
    s_waitcnt vmcnt(9)
    buffer_load_dwordx4 v[176:179], v2, s[60:63], s6 offen offset:0 sc1
    buffer_load_dwordx4 v[180:183], v2, s[60:63], s6 offen offset:1024 sc1
    s_waitcnt vmcnt(5)
    s_nop 0
    ds_read2st64_b32 v[216:217], v1 offset0:0 offset1:4
    ds_read2st64_b32 v[218:219], v1 offset0:8 offset1:12
    ds_read2st64_b32 v[220:221], v1 offset0:16 offset1:20
    ds_read2st64_b32 v[222:223], v1 offset0:24 offset1:28
    ds_read2st64_b32 v[224:225], v1 offset0:32 offset1:36
    ds_read2st64_b32 v[226:227], v4 offset0:0 offset1:4
    ds_read2st64_b32 v[228:229], v4 offset0:8 offset1:12
    s_waitcnt lgkmcnt(0)
Lc_6:
    s_nop 0
    v_perm_b32 v216, v216, v217, s85
    v_perm_b32 v218, v218, v219, s85
    v_perm_b32 v220, v220, v221, s85
    v_perm_b32 v222, v222, v223, s85
    v_perm_b32 v224, v224, v225, s85
    v_perm_b32 v226, v226, v227, s85
    v_perm_b32 v228, v228, v229, s85
    v_max3_u32 v217, v216, v218, v220
    v_min3_u32 v219, v216, v218, v220
    v_max3_u32 v217, v217, v222, v224
    v_min3_u32 v219, v219, v222, v224
    v_max3_u32 v217, v217, v226, v228
    v_min3_u32 v219, v219, v226, v228
    v_cmp_ne_u32 vcc, s69, v217
    v_cmp_ne_u32_e64 s[48:49], s69, v219
    s_nop 0
    s_or_b64 vcc, vcc, s[48:49]
    s_cbranch_scc1 Lr_7
Lk_8:
    s_waitcnt vmcnt(0)
Lc_9:
    v_perm_b32 v248, v179, v183, s85
    v_cmp_ne_u32 vcc, s69, v248
    s_cbranch_vccnz Lr_10
Lk_11:
    v_mfma_f32_16x16x32_bf16 v[244:247], v[212:215], v[176:179], 0
    v_mfma_f32_16x16x32_bf16 v[244:247], v[212:215], v[180:183], v[244:247]
    s_nop 7
    v_add_f32_dpp v244, v244, v244 row_ror:4 row_mask:0xf bank_mask:0xf
    v_add_f32_dpp v245, v245, v245 row_ror:4 row_mask:0xf bank_mask:0xf
    v_add_f32_dpp v246, v246, v246 row_ror:4 row_mask:0xf bank_mask:0xf
    v_add_f32_dpp v247, v247, v247 row_ror:4 row_mask:0xf bank_mask:0xf
    v_add_f32_dpp v244, v244, v244 row_ror:8 row_mask:0xf bank_mask:0xf
    v_add_f32_dpp v245, v245, v245 row_ror:8 row_mask:0xf bank_mask:0xf
    v_add_f32_dpp v246, v246, v246 row_ror:8 row_mask:0xf bank_mask:0xf
    v_add_f32_dpp v247, v247, v247 row_ror:8 row_mask:0xf bank_mask:0xf
    v_cvt_pk_bf16_f32 v251, v246, s86
    v_cvt_pk_bf16_f32 v252, v246, s86
    v_cvt_pk_bf16_f32 v248, v244, v245
    v_cvt_pk_bf16_f32 v250, v244, v245
    v_cvt_pk_bf16_f32 v249, v246, v247
    v_permlane16_swap_b32 v252, v251
    v_permlane16_swap_b32 v248, v250
    buffer_store_dwordx4 v[248:251], v9, s[60:63], s11 offen sc1
    s_barrier
    s_lshl_b32 s12, s2, 2
    s_add_u32 s12, s12, s3
    s_nop 0
    s_mul_i32 s12, s12, 1568
    buffer_load_dwordx4 a[232:235], v2, s[52:55], s12 offen
    buffer_load_dwordx4 a[232:235], v2, s[52:55], s12 offen offset:576
    ds_read_b64_tr_b16 v[192:193], v11 offset:0
    ds_read_b64_tr_b16 v[194:195], v11 offset:512
    ds_read_b64_tr_b16 v[196:197], v11 offset:2048
    ds_read_b64_tr_b16 v[198:199], v11 offset:2560
    ds_read_b64_tr_b16 v[200:201], v11 offset:4096
    ds_read_b64_tr_b16 v[202:203], v11 offset:4608
    ds_read_b64_tr_b16 v[204:205], v11 offset:6144
    ds_read_b64_tr_b16 v[206:207], v11 offset:6656
    s_waitcnt lgkmcnt(6)
    v_mfma_f32_32x32x16_bf16 v[216:231], v[192:195], v[16:19], 0
    s_waitcnt lgkmcnt(4)
    ds_read_b64_tr_b16 v[208:209], v11 offset:8192
    ds_read_b64_tr_b16 v[210:211], v11 offset:8704
    s_mul_i32 s13, s3, 24576
    v_bfe_u32 v4, v0, 4, 1
    v_lshlrev_b32 v4, 6, v4
    v_and_b32 v5, 0x70, v2
    v_mfma_f32_32x32x16_bf16 v[216:231], v[196:199], v[20:23], v[216:231]
    s_waitcnt lgkmcnt(4)
    ds_read_b64_tr_b16 v[192:193], v11 offset:10240
    ds_read_b64_tr_b16 v[194:195], v11 offset:10752
    v_xor_b32 v4, v4, v5
    v_lshrrev_b32 v1, 3, v0
    v_mul_u32_u24 v1, 896, v1
    v_add_u32 v1, v1, v4
    v_mfma_f32_32x32x16_bf16 v[216:231], v[200:203], v[24:27], v[216:231]
    s_waitcnt lgkmcnt(4)
    ds_read_b64_tr_b16 v[196:197], v11 offset:12288
    ds_read_b64_tr_b16 v[198:199], v11 offset:12800
    v_cmp_le_u32 vcc, 56, v0
    v_mov_b32 v5, 2146435072
    s_nop 0
    v_cndmask_b32 v1, v1, v5, vcc
    v_or_b32_e64 v1, s25, v1
    v_mfma_f32_32x32x16_bf16 v[216:231], v[204:207], v[28:31], v[216:231]
    s_waitcnt lgkmcnt(4)
    ds_read_b64_tr_b16 v[200:201], v11 offset:14336
    ds_read_b64_tr_b16 v[202:203], v11 offset:14848
    v_add_u32 v4, 5248, v1
    v_add_u32 v5, 10496, v1
    v_add_u32 v6, 15744, v1
    v_mfma_f32_32x32x16_bf16 v[216:231], v[208:211], v[32:35], v[216:231]
    s_waitcnt lgkmcnt(4)
    ds_read_b64_tr_b16 v[204:205], v11 offset:16384
    ds_read_b64_tr_b16 v[206:207], v11 offset:16896
    s_add_u32 m0, s16, 98304
    s_add_u32 s81, s76, 0
    v_mfma_f32_32x32x16_bf16 v[216:231], v[192:195], v[36:39], v[216:231]
    s_waitcnt lgkmcnt(4)
    ds_read_b64_tr_b16 v[208:209], v11 offset:18432
    ds_read_b64_tr_b16 v[210:211], v11 offset:18944
    buffer_load_dwordx4 v1, s[40:43], s81 offen offset:0  lds
    v_mfma_f32_32x32x16_bf16 v[216:231], v[196:199], v[40:43], v[216:231]
    s_waitcnt lgkmcnt(4)
    ds_read_b64_tr_b16 v[192:193], v11 offset:20480
    ds_read_b64_tr_b16 v[194:195], v11 offset:20992
    buffer_load_dwordx4 v4, s[40:43], s81 offen offset:1024  lds
    v_mfma_f32_32x32x16_bf16 v[216:231], v[200:203], v[44:47], v[216:231]
    s_waitcnt lgkmcnt(4)
    ds_read_b64_tr_b16 v[196:197], v11 offset:22528
    ds_read_b64_tr_b16 v[198:199], v11 offset:23040
    buffer_load_dwordx4 v5, s[40:43], s81 offen offset:2048  lds
    v_mfma_f32_32x32x16_bf16 v[216:231], v[204:207], v[48:51], v[216:231]
    s_waitcnt lgkmcnt(4)
    ds_read_b64_tr_b16 v[200:201], v11 offset:24576
    ds_read_b64_tr_b16 v[202:203], v11 offset:25088
    v_mfma_f32_32x32x16_bf16 v[216:231], v[208:211], v[52:55], v[216:231]
    s_waitcnt lgkmcnt(4)
    ds_read_b64_tr_b16 v[204:205], v11 offset:26624
    ds_read_b64_tr_b16 v[206:207], v11 offset:27136
    buffer_load_dwordx4 v6, s[40:43], s81 offen offset:3072  lds
    v_mfma_f32_32x32x16_bf16 v[216:231], v[192:195], v[56:59], v[216:231]
    s_waitcnt lgkmcnt(4)
    ds_read_b64_tr_b16 v[208:209], v11 offset:28672
    ds_read_b64_tr_b16 v[210:211], v11 offset:29184
    s_add_u32 m0, s16, 102400
    s_add_u32 s81, s76, 25088
    v_mfma_f32_32x32x16_bf16 v[216:231], v[196:199], v[60:63], v[216:231]
    s_waitcnt lgkmcnt(4)
    ds_read_b64_tr_b16 v[192:193], v11 offset:30720
    ds_read_b64_tr_b16 v[194:195], v11 offset:31232
    buffer_load_dwordx4 v1, s[40:43], s81 offen offset:0  lds
    v_mfma_f32_32x32x16_bf16 v[216:231], v[200:203], v[64:67], v[216:231]
    s_waitcnt lgkmcnt(4)
    ds_read_b64_tr_b16 v[196:197], v11 offset:32768
    ds_read_b64_tr_b16 v[198:199], v11 offset:33280
    buffer_load_dwordx4 v4, s[40:43], s81 offen offset:1024  lds
    v_mfma_f32_32x32x16_bf16 v[216:231], v[204:207], v[68:71], v[216:231]
    s_waitcnt lgkmcnt(4)
    ds_read_b64_tr_b16 v[200:201], v11 offset:34816
    ds_read_b64_tr_b16 v[202:203], v11 offset:35328
    v_mfma_f32_32x32x16_bf16 v[216:231], v[208:211], v[72:75], v[216:231]
    s_waitcnt lgkmcnt(4)
    ds_read_b64_tr_b16 v[204:205], v11 offset:36864
    ds_read_b64_tr_b16 v[206:207], v11 offset:37376
    buffer_load_dwordx4 v5, s[40:43], s81 offen offset:2048  lds
    v_mfma_f32_32x32x16_bf16 v[216:231], v[192:195], v[76:79], v[216:231]
    s_waitcnt lgkmcnt(4)
    ds_read_b64_tr_b16 v[208:209], v11 offset:38912
    ds_read_b64_tr_b16 v[210:211], v11 offset:39424
    v_mfma_f32_32x32x16_bf16 v[216:231], v[196:199], v[80:83], v[216:231]
    s_waitcnt lgkmcnt(4)
    ds_read_b64_tr_b16 v[192:193], v11 offset:40960
    ds_read_b64_tr_b16 v[194:195], v11 offset:41472
    buffer_load_dwordx4 v6, s[40:43], s81 offen offset:3072  lds
    v_mfma_f32_32x32x16_bf16 v[216:231], v[200:203], v[84:87], v[216:231]
    s_waitcnt lgkmcnt(4)
    ds_read_b64_tr_b16 v[196:197], v11 offset:43008
    ds_read_b64_tr_b16 v[198:199], v11 offset:43520
    s_add_u32 m0, s16, 106496
    s_add_u32 s81, s76, 50176
    v_mfma_f32_32x32x16_bf16 v[216:231], v[204:207], v[88:91], v[216:231]
    s_waitcnt lgkmcnt(4)
    ds_read_b64_tr_b16 v[200:201], v11 offset:45056
    ds_read_b64_tr_b16 v[202:203], v11 offset:45568
    buffer_load_dwordx4 v1, s[40:43], s81 offen offset:0  lds
    v_mfma_f32_32x32x16_bf16 v[216:231], v[208:211], v[92:95], v[216:231]
    s_waitcnt lgkmcnt(4)
    ds_read_b64_tr_b16 v[204:205], v11 offset:47104
    ds_read_b64_tr_b16 v[206:207], v11 offset:47616
    buffer_load_dwordx4 v4, s[40:43], s81 offen offset:1024  lds
    v_mfma_f32_32x32x16_bf16 v[216:231], v[192:195], v[96:99], v[216:231]
    s_waitcnt lgkmcnt(4)
    ds_read_b64_tr_b16 v[208:209], v11 offset:49152
    ds_read_b64_tr_b16 v[210:211], v11 offset:49664
    v_mfma_f32_32x32x16_bf16 v[216:231], v[196:199], v[100:103], v[216:231]
    s_waitcnt lgkmcnt(4)
    ds_read_b64_tr_b16 v[192:193], v11 offset:51200
    ds_read_b64_tr_b16 v[194:195], v11 offset:51712
    buffer_load_dwordx4 v5, s[40:43], s81 offen offset:2048  lds
    v_mfma_f32_32x32x16_bf16 v[216:231], v[200:203], v[104:107], v[216:231]
    s_waitcnt lgkmcnt(4)
    ds_read_b64_tr_b16 v[196:197], v11 offset:53248
    ds_read_b64_tr_b16 v[198:199], v11 offset:53760
    buffer_load_dwordx4 v6, s[40:43], s81 offen offset:3072  lds
    v_mfma_f32_32x32x16_bf16 v[216:231], v[204:207], v[108:111], v[216:231]
    s_waitcnt lgkmcnt(4)
    ds_read_b64_tr_b16 v[200:201], v11 offset:55296
    ds_read_b64_tr_b16 v[202:203], v11 offset:55808
    v_mfma_f32_32x32x16_bf16 v[216:231], v[208:211], v[112:115], v[216:231]
    s_waitcnt lgkmcnt(4)
    s_add_u32 m0, s16, 110592
    s_add_u32 s81, s76, 75264
    v_mfma_f32_32x32x16_bf16 v[216:231], v[192:195], v[116:119], v[216:231]
    s_waitcnt lgkmcnt(2)
    buffer_load_dwordx4 v1, s[40:43], s81 offen offset:0  lds
    v_mfma_f32_32x32x16_bf16 v[216:231], v[196:199], v[120:123], v[216:231]
    s_waitcnt lgkmcnt(0)
    buffer_load_dwordx4 v4, s[40:43], s81 offen offset:1024  lds
    v_mfma_f32_32x32x16_bf16 v[216:231], v[200:203], v[124:127], v[216:231]
    s_barrier
    s_waitcnt vmcnt(16)
    buffer_load_dwordx4 v[96:99], v2, s[60:63], s10 offen offset:0 sc1
    buffer_load_dwordx4 v[100:103], v2, s[60:63], s10 offen offset:1024 sc1
    buffer_load_dwordx4 v[104:107], v2, s[60:63], s10 offen offset:2048 sc1
    buffer_load_dwordx4 v[108:111], v2, s[60:63], s10 offen offset:3072 sc1
    s_lshl_b32 s78, s21, 6
    v_xor_b32 v124, s78, v3
    v_lshl_add_u32 v92, v7, 9, v124
    s_lshl_b32 s77, s21, 15
    s_add_u32 s77, s77, 98304
    v_add_u32 v92, s77, v92
    v_xor_b32_e64 v93, 64, v92
    v_bfe_u32 v125, v0, 4, 1
    v_lshl_add_u32 v125, v125, 1, s20
    v_lshl_add_u32 v94, v125, 14, v124
    v_add_u32 v94, 98304, v94
    v_cvt_pk_bf16_f32 v160, v216, v217
    v_cvt_pk_bf16_f32 v161, v218, v219
    v_cvt_pk_bf16_f32 v162, v220, v221
    v_cvt_pk_bf16_f32 v163, v222, v223
    v_cvt_pk_bf16_f32 v164, v224, v225
    v_cvt_pk_bf16_f32 v165, v226, v227
    v_cvt_pk_bf16_f32 v166, v228, v229
    v_cvt_pk_bf16_f32 v167, v230, v231
    v_mfma_f32_32x32x16_bf16 v[144:159], v[232:235], v[160:163], 0
    s_nop 0
    v_mfma_f32_32x32x16_bf16 v[144:159], v[236:239], v[164:167], v[144:159]
    v_mul_u32_u24 v10, 24576, v125
    v_lshlrev_b32 v125, 14, v125
    v_add_u32 v10, v10, v124
    v_add_u32 v124, v125, v124
    v_xor_b32 v95, 32, v94
    v_xor_b32 v11, 32, v10
    v_xor_b32 v125, 32, v124
    buffer_load_dwordx4 v5, s[40:43], s81 offen offset:2048  lds
    buffer_load_dwordx4 v6, s[40:43], s81 offen offset:3072  lds
    s_nop 2
    v_max3_f32 v248, v144, v145, v146
    v_min3_f32 v249, v144, v145, v146
    v_max3_f32 v248, v248, v147, v148
    v_min3_f32 v249, v249, v147, v148
    v_max3_f32 v248, v248, v149, v150
    v_min3_f32 v249, v249, v149, v150
    v_max3_f32 v248, v248, v152, v153
    v_min3_f32 v249, v249, v152, v153
    v_max3_f32 v248, v248, v154, v155
    v_min3_f32 v249, v249, v154, v155
    v_max3_f32 v248, v248, v156, v157
    v_min3_f32 v249, v249, v156, v157
    v_max_f32 v248, v248, v158
    v_min_f32 v249, v249, v158
    v_mov_b32 v250, v248
    v_mov_b32 v251, v249
    s_nop 0
    v_permlane32_swap_b32 v248, v250
    v_permlane32_swap_b32 v249, v251
    v_max_f32 v248, v248, v250
    v_min_f32 v249, v249, v251
    v_mul_f32_e64 v248, -v248, s70
    v_mul_f32 v249, s70, v249
    v_pk_fma_f32 v[160:161], v[144:145], s[70:71], v[248:249] op_sel_hi:[1,0,0]
    v_pk_fma_f32 v[176:177], v[144:145], s[70:71], v[248:249] op_sel:[0,0,1] op_sel_hi:[1,0,1] neg_lo:[1,0,0] neg_hi:[1,0,0]
    v_exp_f32 v160, v160
    v_exp_f32 v176, v176
    v_exp_f32 v161, v161
    v_exp_f32 v177, v177
    v_pk_fma_f32 v[162:163], v[146:147], s[70:71], v[248:249] op_sel_hi:[1,0,0]
    v_pk_fma_f32 v[178:179], v[146:147], s[70:71], v[248:249] op_sel:[0,0,1] op_sel_hi:[1,0,1] neg_lo:[1,0,0] neg_hi:[1,0,0]
    v_exp_f32 v162, v162
    s_add_u32 m0, s13, 0
    s_add_u32 s81, s89, 0
    buffer_load_dwordx4 v240, s[44:47], s81 offen offset:0  lds
    buffer_load_dwordx4 v241, s[44:47], s81 offen offset:1024  lds
    v_exp_f32 v178, v178
    v_exp_f32 v163, v163
    v_exp_f32 v179, v179
    v_pk_fma_f32 v[164:165], v[148:149], s[70:71], v[248:249] op_sel_hi:[1,0,0]
    v_pk_fma_f32 v[180:181], v[148:149], s[70:71], v[248:249] op_sel:[0,0,1] op_sel_hi:[1,0,1] neg_lo:[1,0,0] neg_hi:[1,0,0]
    v_exp_f32 v164, v164
    v_exp_f32 v180, v180
    v_exp_f32 v165, v165
    v_exp_f32 v181, v181
    v_pk_fma_f32 v[166:167], v[150:151], s[70:71], v[248:249] op_sel_hi:[1,0,0]
    v_pk_fma_f32 v[182:183], v[150:151], s[70:71], v[248:249] op_sel:[0,0,1] op_sel_hi:[1,0,1] neg_lo:[1,0,0] neg_hi:[1,0,0]
    v_exp_f32 v166, v166
    v_exp_f32 v182, v182
    v_pk_fma_f32 v[168:169], v[152:153], s[70:71], v[248:249] op_sel_hi:[1,0,0]
    v_pk_fma_f32 v[184:185], v[152:153], s[70:71], v[248:249] op_sel:[0,0,1] op_sel_hi:[1,0,1] neg_lo:[1,0,0] neg_hi:[1,0,0]
    v_exp_f32 v168, v168
    v_exp_f32 v184, v184
    v_exp_f32 v169, v169
    v_exp_f32 v185, v185
    v_pk_fma_f32 v[170:171], v[154:155], s[70:71], v[248:249] op_sel_hi:[1,0,0]
    v_pk_fma_f32 v[186:187], v[154:155], s[70:71], v[248:249] op_sel:[0,0,1] op_sel_hi:[1,0,1] neg_lo:[1,0,0] neg_hi:[1,0,0]
    v_exp_f32 v170, v170
    v_exp_f32 v186, v186
    v_exp_f32 v171, v171
    v_exp_f32 v187, v187
    v_pk_fma_f32 v[172:173], v[156:157], s[70:71], v[248:249] op_sel_hi:[1,0,0]
    v_pk_fma_f32 v[188:189], v[156:157], s[70:71], v[248:249] op_sel:[0,0,1] op_sel_hi:[1,0,1] neg_lo:[1,0,0] neg_hi:[1,0,0]
    v_exp_f32 v172, v172
    v_exp_f32 v188, v188
    v_exp_f32 v173, v173
    v_exp_f32 v189, v189
    buffer_load_dwordx4 v242, s[44:47], s81 offen offset:2048  lds
    buffer_load_dwordx4 v243, s[44:47], s81 offen offset:3072  lds
    v_pk_fma_f32 v[174:175], v[158:159], s[70:71], v[248:249] op_sel_hi:[1,0,0]
    v_pk_fma_f32 v[190:191], v[158:159], s[70:71], v[248:249] op_sel:[0,0,1] op_sel_hi:[1,0,1] neg_lo:[1,0,0] neg_hi:[1,0,0]
    v_exp_f32 v174, v174
    v_exp_f32 v190, v190
    v_pk_add_f32 v[252:253], v[160:161], v[162:163]
    v_pk_add_f32 v[254:255], v[176:177], v[178:179]
    v_pk_add_f32 v[252:253], v[252:253], v[164:165]
    v_pk_add_f32 v[254:255], v[254:255], v[180:181]
    v_pk_add_f32 v[252:253], v[252:253], v[168:169]
    v_pk_add_f32 v[254:255], v[254:255], v[184:185]
    v_pk_add_f32 v[252:253], v[252:253], v[170:171]
    v_pk_add_f32 v[254:255], v[254:255], v[186:187]
    v_pk_add_f32 v[252:253], v[252:253], v[172:173]
    v_pk_add_f32 v[254:255], v[254:255], v[188:189]
    v_add_f32 v252, v252, v166
    v_add_f32 v254, v254, v182
    v_add_f32 v253, v253, v174
    v_add_f32 v255, v255, v190
    v_add_f32 v252, v252, v253
    v_add_f32 v254, v254, v255
    v_mov_b32 v250, v252
    v_mov_b32 v251, v254
    s_nop 0
    v_permlane32_swap_b32 v252, v250
    v_permlane32_swap_b32 v254, v251
    v_add_f32 v252, v252, v250
    v_add_f32 v254, v254, v251
    v_rcp_f32 v252, v252
    v_rcp_f32_e64 v254, v254
    v_pk_mul_f32 v[160:161], v[160:161], v[252:253] op_sel_hi:[1,0]
    v_cvt_pk_bf16_f32 v128, v160, v161
    v_pk_mul_f32 v[162:163], v[162:163], v[252:253] op_sel_hi:[1,0]
    s_add_u32 m0, s13, 4096
    s_add_u32 s81, s89, 114688
    buffer_load_dwordx4 v240, s[44:47], s81 offen offset:0  lds
    buffer_load_dwordx4 v241, s[44:47], s81 offen offset:1024  lds
    v_cvt_pk_bf16_f32 v129, v162, v163
    v_pk_mul_f32 v[164:165], v[164:165], v[252:253] op_sel_hi:[1,0]
    v_cvt_pk_bf16_f32 v130, v164, v165
    v_mul_f32_e64 v166, v252, v166
    v_cvt_pk_bf16_f32 v131, v166, 0
    v_pk_mul_f32 v[168:169], v[168:169], v[252:253] op_sel_hi:[1,0]
    v_cvt_pk_bf16_f32 v132, v168, v169
    v_pk_mul_f32 v[170:171], v[170:171], v[252:253] op_sel_hi:[1,0]
    v_cvt_pk_bf16_f32 v133, v170, v171
    v_pk_mul_f32 v[172:173], v[172:173], v[252:253] op_sel_hi:[1,0]
    v_cvt_pk_bf16_f32 v134, v172, v173
    v_mul_f32_e64 v174, v252, v174
    v_cvt_pk_bf16_f32 v135, v174, 0
    v_pk_mul_f32 v[176:177], v[176:177], v[254:255] op_sel_hi:[1,0]
    v_cvt_pk_bf16_f32 v136, v176, v177
    v_pk_mul_f32 v[178:179], v[178:179], v[254:255] op_sel_hi:[1,0]
    v_cvt_pk_bf16_f32 v137, v178, v179
    v_pk_mul_f32 v[180:181], v[180:181], v[254:255] op_sel_hi:[1,0]
    v_cvt_pk_bf16_f32 v138, v180, v181
    v_mul_f32_e64 v182, v254, v182
    v_cvt_pk_bf16_f32 v139, v182, 0
    v_pk_mul_f32 v[184:185], v[184:185], v[254:255] op_sel_hi:[1,0]
    v_cvt_pk_bf16_f32 v140, v184, v185
    v_pk_mul_f32 v[186:187], v[186:187], v[254:255] op_sel_hi:[1,0]
    v_cvt_pk_bf16_f32 v141, v186, v187
    v_pk_mul_f32 v[188:189], v[188:189], v[254:255] op_sel_hi:[1,0]
    v_cvt_pk_bf16_f32 v142, v188, v189
    v_mul_f32 v190, v254, v190
    v_cvt_pk_bf16_f32 v143, v190, 0
    s_waitcnt vmcnt(8)
Lc_12:
    v_perm_b32 v248, v99, v103, s85
    v_perm_b32 v249, v107, v111, s85
    v_cmp_ne_u32 vcc, s69, v248
    v_cmp_ne_u32_e64 s[48:49], s69, v249
    s_nop 0
    s_or_b64 vcc, vcc, s[48:49]
    s_cbranch_scc1 Lr_13
Lk_14:
    v_mfma_f32_32x32x16_bf16 v[160:175], v[96:99], v[128:131], 0
    v_mfma_f32_32x32x16_bf16 v[160:175], v[100:103], v[132:135], v[160:175]
    buffer_load_dwordx4 v242, s[44:47], s81 offen offset:2048  lds
    v_mfma_f32_32x32x16_bf16 v[160:175], v[104:107], v[136:139], v[160:175]
    v_mfma_f32_32x32x16_bf16 v[160:175], v[108:111], v[140:143], v[160:175]
    buffer_load_dwordx4 v243, s[44:47], s81 offen offset:3072  lds
    s_xor_b32 s86, s86, 0x10000
    s_xor_b32 s69, s69, 0x10001
    s_mul_i32 s78, s21, 1114112
    s_mul_i32 s79, s93, 2176
    s_add_u32 s78, s78, s79
    s_add_u32 s78, s78, 1048576
    s_nop 4
    v_add_f32 v248, 0x358637bd, v167
    v_rcp_f32 v248, v248
    s_nop 0
    v_pk_mul_f32 v[160:161], v[160:161], v[248:249] op_sel_hi:[1,0]
    v_pk_mul_f32 v[162:163], v[162:163], v[248:249] op_sel_hi:[1,0]
    v_pk_mul_f32 v[164:165], v[164:165], v[248:249] op_sel_hi:[1,0]
    v_mul_f32_e64 v166, v248, v166
    v_cvt_pk_bf16_f32 v176, v160, v161
    v_cvt_pk_bf16_f32 v177, v162, v163
    v_cvt_pk_bf16_f32 v178, v164, v165
    v_cvt_pk_bf16_f32 v179, v166, s86
    buffer_store_dwordx4 v[176:179], v2, s[60:63], s6 offen offset:0 sc1
    v_pk_mul_f32 v[168:169], v[168:169], v[248:249] op_sel_hi:[1,0]
    v_pk_mul_f32 v[170:171], v[170:171], v[248:249] op_sel_hi:[1,0]
    v_pk_mul_f32 v[172:173], v[172:173], v[248:249] op_sel_hi:[1,0]
    v_mul_f32_e64 v174, v248, v174
    v_cvt_pk_bf16_f32 v180, v168, v169
    v_cvt_pk_bf16_f32 v181, v170, v171
    v_cvt_pk_bf16_f32 v182, v172, v173
    v_cvt_pk_bf16_f32 v183, v174, s86
    buffer_store_dwordx4 v[180:183], v2, s[60:63], s6 offen offset:1024 sc1
    s_cmp_ge_u32 s67, 28
    s_cbranch_scc1 L_spare
    s_add_u32 s77, s23, 65536
    v_add_u32_e64 v101, s77, v2
    v_xor_b32 v98, 0x1000, v101
    s_waitcnt vmcnt(10)
    s_barrier
    s_add_u32 m0, s13, 8192
    s_add_u32 s81, s89, 229376
    buffer_load_dwordx4 v240, s[44:47], s81 offen offset:0  lds
    ds_read_b64_tr_b16 v[16:17], v92 offset:0
    ds_read_b64_tr_b16 v[18:19], v92 offset:512
    ds_read_b64_tr_b16 v[20:21], v93 offset:0
    ds_read_b64_tr_b16 v[22:23], v93 offset:512
    buffer_load_dwordx4 v241, s[44:47], s81 offen offset:1024  lds
    ds_read_b64_tr_b16 v[24:25], v92 offset:2048
    ds_read_b64_tr_b16 v[26:27], v92 offset:2560
    ds_read_b64_tr_b16 v[28:29], v93 offset:2048
    ds_read_b64_tr_b16 v[30:31], v93 offset:2560
    buffer_load_dwordx4 v242, s[44:47], s81 offen offset:2048  lds
    ds_read_b64_tr_b16 v[32:33], v92 offset:4096
    ds_read_b64_tr_b16 v[34:35], v92 offset:4608
    ds_read_b64_tr_b16 v[36:37], v93 offset:4096
    ds_read_b64_tr_b16 v[38:39], v93 offset:4608
    buffer_load_dwordx4 v243, s[44:47], s81 offen offset:3072  lds
    ds_read_b64_tr_b16 v[40:41], v92 offset:6144
    ds_read_b64_tr_b16 v[42:43], v92 offset:6656
    ds_read_b64_tr_b16 v[44:45], v93 offset:6144
    ds_read_b64_tr_b16 v[46:47], v93 offset:6656
    s_add_u32 m0, s13, 12288
    s_add_u32 s81, s89, 344064
    buffer_load_dwordx4 v240, s[44:47], s81 offen offset:0  lds
    ds_read_b64_tr_b16 v[48:49], v92 offset:8192
    ds_read_b64_tr_b16 v[50:51], v92 offset:8704
    ds_read_b64_tr_b16 v[52:53], v93 offset:8192
    ds_read_b64_tr_b16 v[54:55], v93 offset:8704
    buffer_load_dwordx4 v241, s[44:47], s81 offen offset:1024  lds
    ds_read_b64_tr_b16 v[56:57], v92 offset:10240
    ds_read_b64_tr_b16 v[58:59], v92 offset:10752
    ds_read_b64_tr_b16 v[60:61], v93 offset:10240
    ds_read_b64_tr_b16 v[62:63], v93 offset:10752
    buffer_load_dwordx4 v242, s[44:47], s81 offen offset:2048  lds
    ds_read_b64_tr_b16 v[64:65], v92 offset:12288
    ds_read_b64_tr_b16 v[66:67], v92 offset:12800
    ds_read_b64_tr_b16 v[68:69], v93 offset:12288
    ds_read_b64_tr_b16 v[70:71], v93 offset:12800
    buffer_load_dwordx4 v243, s[44:47], s81 offen offset:3072  lds
    ds_read_b64_tr_b16 v[72:73], v92 offset:14336
    ds_read_b64_tr_b16 v[74:75], v92 offset:14848
    ds_read_b64_tr_b16 v[76:77], v93 offset:14336
    ds_read_b64_tr_b16 v[78:79], v93 offset:14848
    s_add_u32 m0, s13, 16384
    s_add_u32 s81, s89, 458752
    buffer_load_dwordx4 v240, s[44:47], s81 offen offset:0  lds
    ds_read_b64_tr_b16 a[80:81], v92 offset:16384
    ds_read_b64_tr_b16 a[82:83], v92 offset:16896
    ds_read_b64_tr_b16 a[192:193], v93 offset:16384
    ds_read_b64_tr_b16 a[194:195], v93 offset:16896
    buffer_load_dwordx4 v241, s[44:47], s81 offen offset:1024  lds
    ds_read_b64_tr_b16 a[84:85], v92 offset:18432
    ds_read_b64_tr_b16 a[86:87], v92 offset:18944
    ds_read_b64_tr_b16 a[196:197], v93 offset:18432
    ds_read_b64_tr_b16 a[198:199], v93 offset:18944
    buffer_load_dwordx4 v242, s[44:47], s81 offen offset:2048  lds
    ds_read_b64_tr_b16 a[88:89], v92 offset:20480
    ds_read_b64_tr_b16 a[90:91], v92 offset:20992
    ds_read_b64_tr_b16 a[200:201], v93 offset:20480
    ds_read_b64_tr_b16 a[202:203], v93 offset:20992
    buffer_load_dwordx4 v243, s[44:47], s81 offen offset:3072  lds
    ds_read_b64_tr_b16 a[92:93], v92 offset:22528
    ds_read_b64_tr_b16 a[94:95], v92 offset:23040
    ds_read_b64_tr_b16 a[204:205], v93 offset:22528
    ds_read_b64_tr_b16 a[206:207], v93 offset:23040
    s_add_u32 m0, s13, 20480
    s_add_u32 s81, s89, 573440
    buffer_load_dwordx4 v240, s[44:47], s81 offen offset:0  lds
    ds_read_b64_tr_b16 a[96:97], v92 offset:24576
    ds_read_b64_tr_b16 a[98:99], v92 offset:25088
    ds_read_b64_tr_b16 a[208:209], v93 offset:24576
    ds_read_b64_tr_b16 a[210:211], v93 offset:25088
    buffer_load_dwordx4 v241, s[44:47], s81 offen offset:1024  lds
    ds_read_b64_tr_b16 a[100:101], v92 offset:26624
    ds_read_b64_tr_b16 a[102:103], v92 offset:27136
    ds_read_b64_tr_b16 a[212:213], v93 offset:26624
    ds_read_b64_tr_b16 a[214:215], v93 offset:27136
    buffer_load_dwordx4 v242, s[44:47], s81 offen offset:2048  lds
    ds_read_b64_tr_b16 a[104:105], v92 offset:28672
    ds_read_b64_tr_b16 a[106:107], v92 offset:29184
    ds_read_b64_tr_b16 a[216:217], v93 offset:28672
    ds_read_b64_tr_b16 a[218:219], v93 offset:29184
    buffer_load_dwordx4 v243, s[44:47], s81 offen offset:3072  lds
    ds_read_b64_tr_b16 a[108:109], v92 offset:30720
    ds_read_b64_tr_b16 a[110:111], v92 offset:31232
    ds_read_b64_tr_b16 a[220:221], v93 offset:30720
    ds_read_b64_tr_b16 a[222:223], v93 offset:31232
    s_waitcnt lgkmcnt(0)
    s_barrier
    s_waitcnt vmcnt(16)
    s_add_u32 s82, s78, 0
    buffer_load_dwordx4 v[128:131], v2, s[60:63], s82 offen offset:0 sc1
    buffer_load_dwordx4 v[132:135], v2, s[60:63], s82 offen offset:1024 sc1
    s_add_u32 s82, s78, 139264
    buffer_load_dwordx4 v[136:139], v2, s[60:63], s82 offen offset:0 sc1
    buffer_load_dwordx4 v[140:143], v2, s[60:63], s82 offen offset:1024 sc1
    s_add_u32 s82, s78, 278528
    buffer_load_dwordx4 v[144:147], v2, s[60:63], s82 offen offset:0 sc1
    buffer_load_dwordx4 v[148:151], v2, s[60:63], s82 offen offset:1024 sc1
    s_add_u32 s82, s78, 417792
    buffer_load_dwordx4 v[152:155], v2, s[60:63], s82 offen offset:0 sc1
    buffer_load_dwordx4 v[156:159], v2, s[60:63], s82 offen offset:1024 sc1
    v_accvgpr_read_b32 v80, a224
    v_accvgpr_read_b32 v81, a225
    v_accvgpr_read_b32 v82, a226
    v_accvgpr_read_b32 v83, a227
    v_accvgpr_read_b32 v84, a228
    v_accvgpr_read_b32 v85, a229
    v_accvgpr_read_b32 v86, a230
    v_accvgpr_read_b32 v87, a231
    v_bfe_u32 v4, v0, 4, 2
    v_lshlrev_b32 v4, 5, v4
    v_and_b32 v5, 0x70, v2
    v_xor_b32 v4, v4, v5
    v_lshrrev_b32 v1, 3, v0
    v_mul_u32_u24 v1, 896, v1
    v_add_u32 v1, v1, v4
    v_add_u32 v4, 6144, v1
    v_add_u32 v5, 26624, v1
    v_add_u32 v6, 32768, v1
    v_lshlrev_b32 v192, 16, v80
    v_and_b32 v193, s71, v80
    v_lshlrev_b32 v194, 16, v81
    v_and_b32 v195, s71, v81
    v_lshlrev_b32 v196, 16, v82
    v_and_b32 v197, s71, v82
    v_lshlrev_b32 v198, 16, v83
    v_and_b32 v199, s71, v83
    v_lshlrev_b32 v200, 16, v84
    v_and_b32 v201, s71, v84
    v_lshlrev_b32 v202, 16, v85
    v_and_b32 v203, s71, v85
    v_lshlrev_b32 v204, 16, v86
    v_and_b32 v205, s71, v86
    v_lshlrev_b32 v206, 16, v87
    v_and_b32 v207, s71, v87
    s_add_u32 s82, s78, 557056
    buffer_load_dwordx4 v[160:163], v2, s[60:63], s82 offen offset:0 sc1
    buffer_load_dwordx4 v[164:167], v2, s[60:63], s82 offen offset:1024 sc1
    s_add_u32 s82, s78, 696320
    buffer_load_dwordx4 v[168:171], v2, s[60:63], s82 offen offset:0 sc1
    buffer_load_dwordx4 v[172:175], v2, s[60:63], s82 offen offset:1024 sc1
    s_add_u32 s82, s78, 835584
    buffer_load_dwordx4 v[176:179], v2, s[60:63], s82 offen offset:0 sc1
    buffer_load_dwordx4 v[180:183], v2, s[60:63], s82 offen offset:1024 sc1
    s_add_u32 s82, s78, 974848
    buffer_load_dwordx4 v[184:187], v2, s[60:63], s82 offen offset:0 sc1
    buffer_load_dwordx4 v[188:191], v2, s[60:63], s82 offen offset:1024 sc1
    s_waitcnt vmcnt(12)
Lc_15:
    v_perm_b32 v102, v131, v135, s85
    v_perm_b32 v103, v139, v143, s85
    v_cmp_ne_u32 vcc, s69, v102
    v_cmp_ne_u32_e64 s[48:49], s69, v103
    s_nop 0
    s_or_b64 vcc, vcc, s[48:49]
    s_cbranch_scc1 Lr_16
Lk_17:
    v_mfma_f32_32x32x16_bf16 v[192:207], v[16:19], v[128:131], v[192:207]
    v_mfma_f32_32x32x16_bf16 v[208:223], v[20:23], v[128:131], 0
    v_mfma_f32_32x32x16_bf16 v[192:207], v[24:27], v[132:135], v[192:207]
    s_add_u32 m0, s16, 98304
    s_add_u32 s81, s89, 688128
L_pb0:
    s_cbranch_execz L_wr_r
    v_mfma_f32_32x32x16_bf16 v[208:223], v[28:31], v[132:135], v[208:223]
    buffer_load_dwordx4 v240, s[44:47], s81 offen offset:0  lds
    v_mfma_f32_32x32x16_bf16 v[192:207], v[32:35], v[136:139], v[192:207]
    v_mfma_f32_32x32x16_bf16 v[208:223], v[36:39], v[136:139], v[208:223]
    buffer_load_dwordx4 v241, s[44:47], s81 offen offset:1024  lds
    v_mfma_f32_32x32x16_bf16 v[192:207], v[40:43], v[140:143], v[192:207]
    s_waitcnt vmcnt(10)
Lc_18:
    v_perm_b32 v102, v147, v151, s85
    v_perm_b32 v103, v155, v159, s85
    v_cmp_ne_u32 vcc, s69, v102
    v_cmp_ne_u32_e64 s[48:49], s69, v103
    s_nop 0
    s_or_b64 vcc, vcc, s[48:49]
    s_cbranch_scc1 Lr_19
Lk_20:
    v_mfma_f32_32x32x16_bf16 v[208:223], v[44:47], v[140:143], v[208:223]
    s_barrier
    v_mfma_f32_32x32x16_bf16 v[192:207], v[48:51], v[144:147], v[192:207]
    buffer_load_dwordx4 v242, s[44:47], s81 offen offset:2048  lds
    ds_read_b64_tr_b16 a[0:1], v10 offset:0
    ds_read_b64_tr_b16 a[2:3], v10 offset:1024
    ds_read_b64_tr_b16 a[112:113], v11 offset:0
    ds_read_b64_tr_b16 a[114:115], v11 offset:1024
    v_mfma_f32_32x32x16_bf16 v[208:223], v[52:55], v[144:147], v[208:223]
    ds_read_b64_tr_b16 a[4:5], v10 offset:2048
    ds_read_b64_tr_b16 a[6:7], v10 offset:3072
    ds_read_b64_tr_b16 a[116:117], v11 offset:2048
    ds_read_b64_tr_b16 a[118:119], v11 offset:3072
    v_mfma_f32_32x32x16_bf16 v[192:207], v[56:59], v[148:151], v[192:207]
    ds_read_b64_tr_b16 a[8:9], v10 offset:4096
    ds_read_b64_tr_b16 a[10:11], v10 offset:5120
    ds_read_b64_tr_b16 a[120:121], v11 offset:4096
    ds_read_b64_tr_b16 a[122:123], v11 offset:5120
    v_mfma_f32_32x32x16_bf16 v[208:223], v[60:63], v[148:151], v[208:223]
    buffer_load_dwordx4 v243, s[44:47], s81 offen offset:3072  lds
    ds_read_b64_tr_b16 a[12:13], v10 offset:6144
    ds_read_b64_tr_b16 a[14:15], v10 offset:7168
    ds_read_b64_tr_b16 a[124:125], v11 offset:6144
    ds_read_b64_tr_b16 a[126:127], v11 offset:7168
    v_mfma_f32_32x32x16_bf16 v[192:207], v[64:67], v[152:155], v[192:207]
    ds_read_b64_tr_b16 a[16:17], v10 offset:8192
    ds_read_b64_tr_b16 a[18:19], v10 offset:9216
    ds_read_b64_tr_b16 a[128:129], v11 offset:8192
    ds_read_b64_tr_b16 a[130:131], v11 offset:9216
    v_mfma_f32_32x32x16_bf16 v[208:223], v[68:71], v[152:155], v[208:223]
    ds_read_b64_tr_b16 a[20:21], v10 offset:10240
    ds_read_b64_tr_b16 a[22:23], v10 offset:11264
    ds_read_b64_tr_b16 a[132:133], v11 offset:10240
    ds_read_b64_tr_b16 a[134:135], v11 offset:11264
    v_mfma_f32_32x32x16_bf16 v[192:207], v[72:75], v[156:159], v[192:207]
    s_waitcnt vmcnt(8)
    ds_read_b64_tr_b16 a[24:25], v10 offset:12288
    ds_read_b64_tr_b16 a[26:27], v10 offset:13312
    ds_read_b64_tr_b16 a[136:137], v11 offset:12288
    ds_read_b64_tr_b16 a[138:139], v11 offset:13312
Lc_21:
    v_perm_b32 v102, v163, v167, s85
    v_perm_b32 v103, v171, v175, s85
    v_cmp_ne_u32 vcc, s69, v102
    v_cmp_ne_u32_e64 s[48:49], s69, v103
    s_nop 0
    s_or_b64 vcc, vcc, s[48:49]
    s_cbranch_scc1 Lr_22
Lk_23:
    v_mfma_f32_32x32x16_bf16 v[208:223], v[76:79], v[156:159], v[208:223]
    ds_read_b64_tr_b16 a[28:29], v10 offset:14336
    ds_read_b64_tr_b16 a[30:31], v10 offset:15360
    ds_read_b64_tr_b16 a[140:141], v11 offset:14336
    ds_read_b64_tr_b16 a[142:143], v11 offset:15360
    s_add_u32 m0, s16, 102400
    s_add_u32 s81, s89, 802816
    v_mfma_f32_32x32x16_bf16 v[192:207], a[80:83], v[160:163], v[192:207]
    buffer_load_dwordx4 v240, s[44:47], s81 offen offset:0  lds
    ds_read_b64_tr_b16 a[32:33], v10 offset:16384
    ds_read_b64_tr_b16 a[34:35], v10 offset:17408
    ds_read_b64_tr_b16 a[144:145], v11 offset:16384
    ds_read_b64_tr_b16 a[146:147], v11 offset:17408
    v_mfma_f32_32x32x16_bf16 v[208:223], a[192:195], v[160:163], v[208:223]
    buffer_load_dwordx4 v241, s[44:47], s81 offen offset:1024  lds
    ds_read_b64_tr_b16 a[36:37], v10 offset:18432
    ds_read_b64_tr_b16 a[38:39], v10 offset:19456
    ds_read_b64_tr_b16 a[148:149], v11 offset:18432
    ds_read_b64_tr_b16 a[150:151], v11 offset:19456
    v_mfma_f32_32x32x16_bf16 v[192:207], a[84:87], v[164:167], v[192:207]
    ds_read_b64_tr_b16 a[40:41], v10 offset:20480
    ds_read_b64_tr_b16 a[42:43], v10 offset:21504
    ds_read_b64_tr_b16 a[152:153], v11 offset:20480
    ds_read_b64_tr_b16 a[154:155], v11 offset:21504
    v_mfma_f32_32x32x16_bf16 v[208:223], a[196:199], v[164:167], v[208:223]
    ds_read_b64_tr_b16 a[44:45], v10 offset:22528
    ds_read_b64_tr_b16 a[46:47], v10 offset:23552
    ds_read_b64_tr_b16 a[156:157], v11 offset:22528
    ds_read_b64_tr_b16 a[158:159], v11 offset:23552
    v_mfma_f32_32x32x16_bf16 v[192:207], a[88:91], v[168:171], v[192:207]
    buffer_load_dwordx4 v242, s[44:47], s81 offen offset:2048  lds
    v_mfma_f32_32x32x16_bf16 v[208:223], a[200:203], v[168:171], v[208:223]
    v_mfma_f32_32x32x16_bf16 v[192:207], a[92:95], v[172:175], v[192:207]
    s_waitcnt vmcnt(7)
Lc_24:
    v_perm_b32 v102, v179, v183, s85
    v_perm_b32 v103, v187, v191, s85
    v_cmp_ne_u32 vcc, s69, v102
    v_cmp_ne_u32_e64 s[48:49], s69, v103
    s_nop 0
    s_or_b64 vcc, vcc, s[48:49]
    s_cbranch_scc1 Lr_25
Lk_26:
    v_mfma_f32_32x32x16_bf16 v[208:223], a[204:207], v[172:175], v[208:223]
    buffer_load_dwordx4 v243, s[44:47], s81 offen offset:3072  lds
    v_mfma_f32_32x32x16_bf16 v[192:207], a[96:99], v[176:179], v[192:207]
    v_mfma_f32_32x32x16_bf16 v[208:223], a[208:211], v[176:179], v[208:223]
    v_mfma_f32_32x32x16_bf16 v[192:207], a[100:103], v[180:183], v[192:207]
    s_add_u32 m0, s16, 106496
    s_add_u32 s81, s89, 917504
    v_mfma_f32_32x32x16_bf16 v[208:223], a[212:215], v[180:183], v[208:223]
    buffer_load_dwordx4 v240, s[44:47], s81 offen offset:0  lds
    v_mfma_f32_32x32x16_bf16 v[192:207], a[104:107], v[184:187], v[192:207]
    v_mfma_f32_32x32x16_bf16 v[208:223], a[216:219], v[184:187], v[208:223]
    buffer_load_dwordx4 v241, s[44:47], s81 offen offset:1024  lds
    v_mfma_f32_32x32x16_bf16 v[208:223], a[220:223], v[188:191], v[208:223]
    v_mfma_f32_32x32x16_bf16 v[192:207], a[108:111], v[188:191], v[192:207]
    buffer_load_dwordx4 v242, s[44:47], s81 offen offset:2048  lds
    buffer_load_dwordx4 v243, s[44:47], s81 offen offset:3072  lds
    s_waitcnt lgkmcnt(0)
    s_barrier
    s_nop 6
    s_nop 0
    ds_write_b128 v98, v[208:211] offset:0
    ds_write_b128 v98, v[212:215] offset:1024
    ds_write_b128 v98, v[216:219] offset:2048
    ds_write_b128 v98, v[220:223] offset:3072
    s_add_u32 m0, s16, 110592
    s_add_u32 s81, s89, 1032192
    buffer_load_dwordx4 v240, s[44:47], s81 offen offset:0  lds
    buffer_load_dwordx4 v241, s[44:47], s81 offen offset:1024  lds
    s_waitcnt lgkmcnt(0)
    s_barrier
    ds_read_b128 v[128:131], v101 offset:0
    ds_read_b128 v[132:135], v101 offset:1024
    ds_read_b128 v[136:139], v101 offset:2048
    ds_read_b128 v[140:143], v101 offset:3072
    buffer_load_dwordx4 v242, s[44:47], s81 offen offset:2048  lds
    buffer_load_dwordx4 v243, s[44:47], s81 offen offset:3072  lds
    s_waitcnt lgkmcnt(2)
    s_nop 0
    v_pk_add_f32 v[192:193], v[192:193], v[128:129]
    v_pk_add_f32 v[194:195], v[194:195], v[130:131]
    v_pk_add_f32 v[196:197], v[196:197], v[132:133]
    v_pk_add_f32 v[198:199], v[198:199], v[134:135]
    v_cvt_pk_bf16_f32 v176, v192, v193
    v_cvt_pk_bf16_f32 v177, v194, v195
    v_cvt_pk_bf16_f32 v178, v196, v197
    v_cvt_pk_bf16_f32 v179, v198, v199
    buffer_store_dwordx4 v[176:179], v2, s[60:63], s14 offen offset:0 sc1
    s_waitcnt lgkmcnt(0)
    s_nop 0
    v_pk_add_f32 v[200:201], v[200:201], v[136:137]
    v_pk_add_f32 v[202:203], v[202:203], v[138:139]
    v_pk_add_f32 v[204:205], v[204:205], v[140:141]
    v_pk_add_f32 v[206:207], v[206:207], v[142:143]
    v_cvt_pk_bf16_f32 v180, v200, v201
    v_cvt_pk_bf16_f32 v181, v202, v203
    v_cvt_pk_bf16_f32 v182, v204, v205
    v_cvt_pk_bf16_f32 v183, v206, v207
    buffer_store_dwordx4 v[180:183], v2, s[60:63], s14 offen offset:1024 sc1
    v_pk_add_f32 v[104:105], v[192:193], v[194:195]
    v_pk_mul_f32 v[106:107], v[192:193], v[192:193]
    v_pk_fma_f32 v[106:107], v[194:195], v[194:195], v[106:107]
    v_pk_add_f32 v[104:105], v[104:105], v[196:197]
    v_pk_fma_f32 v[106:107], v[196:197], v[196:197], v[106:107]
    v_pk_add_f32 v[104:105], v[104:105], v[198:199]
    v_pk_fma_f32 v[106:107], v[198:199], v[198:199], v[106:107]
    v_pk_add_f32 v[104:105], v[104:105], v[200:201]
    v_pk_fma_f32 v[106:107], v[200:201], v[200:201], v[106:107]
    v_pk_add_f32 v[104:105], v[104:105], v[202:203]
    v_pk_fma_f32 v[106:107], v[202:203], v[202:203], v[106:107]
    v_pk_add_f32 v[104:105], v[104:105], v[204:205]
    v_pk_fma_f32 v[106:107], v[204:205], v[204:205], v[106:107]
    v_pk_add_f32 v[104:105], v[104:105], v[206:207]
    v_pk_fma_f32 v[106:107], v[206:207], v[206:207], v[106:107]
    v_add_f32 v104, v104, v105
    v_add_f32 v105, v106, v107
    v_lshlrev_b32 v112, 2, v0
    s_nop 0
    v_permlane32_swap_b32 v104, v105
    v_add_f32 v103, v104, v105
    v_mov_b32 v102, v112
    s_add_u32 m0, s16, 0
    s_add_u32 s81, s89, 1146880
    buffer_load_dwordx4 v240, s[44:47], s81 offen offset:0  lds
    buffer_load_dwordx4 v241, s[44:47], s81 offen offset:1024  lds
    s_lshl_b32 s76, s26, 2
    s_add_u32 s76, s76, s3
    s_lshl_b32 s9, s76, 7
    s_add_u32 s9, s9, 720896
    s_lshl_b32 s10, s76, 6
    s_mul_i32 s78, s95, 458752
    s_lshl_b32 s77, s76, 10
    s_add_u32 s78, s78, s77
    s_add_u32 s78, s78, 10485760
    s_mul_i32 s76, s95, 114688
    s_add_u32 s76, s76, s87
    s_add_u32 s76, s76, 8388608
    v_add_u32 v254, 65536, v2
    v_add_u32 v255, s87, v254
    v_lshlrev_b32 v9, 4, v8
    v_add_u32 v9, 94208, v9
    s_and_b32 s79, s83, 3
    s_lshr_b32 s77, s79, 1
    s_and_b32 s79, s79, 1
    s_lshl_b32 s65, s68, 1
    s_add_u32 s65, s65, s77
    s_lshl_b32 s20, s65, 12
    s_mul_i32 s21, s3, 896
    s_add_u32 s20, s20, s21
    s_add_u32 s20, s20, 655360
    s_lshl_b32 s21, s95, 12
    s_add_u32 s10, s10, s21
    s_add_u32 s10, s10, 655360
    s_lshl_b32 s65, s65, 2
    s_add_u32 s65, s65, s79
    s_lshl_b32 s77, s95, 2
    s_add_u32 s77, s77, s3
    s_lshl_b32 s77, s77, 12
    s_add_u32 s77, s77, 131072
    s_mul_i32 s79, s65, 114688
    s_add_u32 s79, s79, s90
    s_add_u32 s79, s79, 10485760
    buffer_load_dwordx4 v242, s[44:47], s81 offen offset:2048  lds
    buffer_load_dwordx4 v243, s[44:47], s81 offen offset:3072  lds
    s_lshl_b32 s11, s26, 7
    s_add_u32 s11, s11, 753664
    s_lshl_b32 s90, s3, 13
    s_add_u32 s90, s90, 131072
    v_lshlrev_b32 v115, 6, v0
    v_mov_b32 v12, v15
    s_lshr_b32 s14, s65, 2
    s_sub_u32 s14, s14, 1
    v_mov_b32 v114, s14
    v_mov_b32 v113, s95
    v_cmp_gt_u32 vcc, 8, v0
    s_nop 1
    v_cndmask_b32 v113, v114, v113, vcc
    v_lshl_add_u32 v115, v113, 9, v115
    s_mov_b32 s14, 770048
    s_nop 0
    v_bfe_u32 v10, v0, 2, 3
    v_bfe_u32 v11, v0, 3, 2
    v_xor_b32 v11, s3, v11
    v_lshlrev_b32 v11, 5, v11
    v_lshl_add_u32 v10, v10, 7, v11
    v_and_b32 v11, 3, v0
    v_lshl_add_u32 v10, v11, 3, v10
    v_lshl_add_u32 v10, v7, 11, v10
    v_add_u32 v10, s90, v10
    v_xor_b32 v11, 32, v10
    v_xor_b32 v113, 64, v10
    v_xor_b32 v114, 0x60, v10
    s_sub_u32 s92, s90, s16
    v_and_b32 v3, 15, v0
    v_lshlrev_b32 v3, 4, v3
    v_lshrrev_b32 v111, 4, v0
    v_lshl_add_u32 v3, v111, 9, v3
    s_add_u32 s7, s90, 4096
    v_add_u32 v112, s7, v112
    v_lshlrev_b32 v176, 6, v0
    v_mov_b32 v179, v15
    v_mul_u32_u24 v177, 7168, v7
    v_lshl_add_u32 v177, v8, 2, v177
    s_lshl_b32 s8, s3, 8
    s_add_u32 s8, s8, 96256
    v_lshl_add_u32 v178, v7, 4, s8
    v_mov_b32 v180, -1
    v_mov_b32 v181, -1
    v_mov_b32 v182, -1
    v_mov_b32 v183, -1
    s_waitcnt vmcnt(6)
    s_barrier
    s_add_u32 m0, s16, 4096
    s_add_u32 s81, s89, 1261568
    buffer_load_dwordx4 v240, s[44:47], s81 offen offset:0  lds
    ds_read_b64_tr_b16 a[48:49], v94 offset:0
    ds_read_b64_tr_b16 a[50:51], v94 offset:1024
    ds_read_b64_tr_b16 a[160:161], v95 offset:0
    ds_read_b64_tr_b16 a[162:163], v95 offset:1024
    buffer_load_dwordx4 v241, s[44:47], s81 offen offset:1024  lds
    ds_read_b64_tr_b16 a[52:53], v94 offset:2048
    ds_read_b64_tr_b16 a[54:55], v94 offset:3072
    ds_read_b64_tr_b16 a[164:165], v95 offset:2048
    ds_read_b64_tr_b16 a[166:167], v95 offset:3072
    buffer_load_dwordx4 v242, s[44:47], s81 offen offset:2048  lds
    ds_read_b64_tr_b16 a[56:57], v94 offset:4096
    ds_read_b64_tr_b16 a[58:59], v94 offset:5120
    ds_read_b64_tr_b16 a[168:169], v95 offset:4096
    ds_read_b64_tr_b16 a[170:171], v95 offset:5120
    buffer_load_dwordx4 v243, s[44:47], s81 offen offset:3072  lds
    ds_read_b64_tr_b16 a[60:61], v94 offset:6144
    ds_read_b64_tr_b16 a[62:63], v94 offset:7168
    ds_read_b64_tr_b16 a[172:173], v95 offset:6144
    ds_read_b64_tr_b16 a[174:175], v95 offset:7168
    s_add_u32 m0, s16, 8192
    s_add_u32 s81, s89, 1376256
    buffer_load_dwordx4 v240, s[44:47], s81 offen offset:0  lds
    ds_read_b64_tr_b16 a[64:65], v94 offset:8192
    ds_read_b64_tr_b16 a[66:67], v94 offset:9216
    ds_read_b64_tr_b16 a[176:177], v95 offset:8192
    ds_read_b64_tr_b16 a[178:179], v95 offset:9216
    buffer_load_dwordx4 v241, s[44:47], s81 offen offset:1024  lds
    ds_read_b64_tr_b16 a[68:69], v94 offset:10240
    ds_read_b64_tr_b16 a[70:71], v94 offset:11264
    ds_read_b64_tr_b16 a[180:181], v95 offset:10240
    ds_read_b64_tr_b16 a[182:183], v95 offset:11264
    buffer_load_dwordx4 v242, s[44:47], s81 offen offset:2048  lds
    ds_read_b64_tr_b16 a[72:73], v94 offset:12288
    ds_read_b64_tr_b16 a[74:75], v94 offset:13312
    ds_read_b64_tr_b16 a[184:185], v95 offset:12288
    ds_read_b64_tr_b16 a[186:187], v95 offset:13312
    buffer_load_dwordx4 v243, s[44:47], s81 offen offset:3072  lds
    ds_read_b64_tr_b16 a[76:77], v94 offset:14336
    ds_read_b64_tr_b16 a[78:79], v94 offset:15360
    ds_read_b64_tr_b16 a[188:189], v95 offset:14336
    ds_read_b64_tr_b16 a[190:191], v95 offset:15360
    s_waitcnt vmcnt(12)
    s_add_u32 m0, s87, 65536
    s_add_u32 s81, s76, 0
    buffer_load_dwordx4 v2, s[60:63], s81 offen offset:0 sc1 lds
    buffer_load_dwordx4 v2, s[60:63], s81 offen offset:1024 sc1 lds
    buffer_load_dwordx4 v2, s[60:63], s81 offen offset:2048 sc1 lds
    buffer_load_dwordx4 v2, s[60:63], s81 offen offset:3072 sc1 lds
    s_add_u32 m0, s87, 69632
    s_add_u32 s81, s76, 4096
    buffer_load_dwordx4 v2, s[60:63], s81 offen offset:0 sc1 lds
    buffer_load_dwordx4 v2, s[60:63], s81 offen offset:1024 sc1 lds
    buffer_load_dwordx4 v2, s[60:63], s81 offen offset:2048 sc1 lds
    s_add_u32 m0, s16, 12288
    s_add_u32 s81, s89, 1490944
    buffer_load_dwordx4 v240, s[44:47], s81 offen offset:0  lds
    buffer_load_dwordx4 v241, s[44:47], s81 offen offset:1024  lds
    buffer_load_dwordx4 v242, s[44:47], s81 offen offset:2048  lds
    buffer_load_dwordx4 v243, s[44:47], s81 offen offset:3072  lds
    buffer_store_dword v103, v102, s[60:63], s15 offen sc1
La_27:
    s_mov_b64 exec, 3
    buffer_load_dword v179, v176, s[60:63], s11 offen sc1
    s_mov_b64 exec, -1
Lb_28:
    s_waitcnt vmcnt(9)
    ds_read_b128 v[16:19], v255 offset:0
    ds_read_b128 v[20:23], v255 offset:1024
    ds_read_b128 v[24:27], v255 offset:2048
    ds_read_b128 v[28:31], v255 offset:3072
    s_waitcnt vmcnt(6)
    ds_read_b128 v[32:35], v255 offset:4096
    ds_read_b128 v[36:39], v255 offset:5120
    ds_read_b128 v[40:43], v255 offset:6144
    s_waitcnt lgkmcnt(0)
Lc_29:
    v_max3_u32 v111, v16, v20, v24
    v_max3_u32 v111, v111, v28, v32
    v_max3_u32 v111, v111, v36, v40
    v_cmp_eq_u32 vcc, -1, v111
    s_cbranch_vccnz Lr_30
Lk_31:
    s_barrier
    ds_read_b128 v[224:227], v254 offset:0
    ds_read_b128 v[228:231], v254 offset:1024
    ds_read_b128 v[232:235], v254 offset:2048
    ds_read_b128 v[236:239], v254 offset:3072
    ds_read_b128 v[240:243], v254 offset:4096
    s_add_u32 m0, s87, 98304
    s_add_u32 s81, s76, 28672
    buffer_load_dwordx4 v2, s[60:63], s81 offen offset:0 sc1 lds
    buffer_load_dwordx4 v2, s[60:63], s81 offen offset:1024 sc1 lds
    s_waitcnt lgkmcnt(4)
    v_mfma_f32_32x32x16_bf16 v[128:143], a[0:3], v[224:227], 0
    s_waitcnt lgkmcnt(3)
    ds_read_b128 v[244:247], v254 offset:5120
    buffer_load_dwordx4 v2, s[60:63], s81 offen offset:2048 sc1 lds
    v_mfma_f32_32x32x16_bf16 v[144:159], a[112:115], v[224:227], 0
    v_mfma_f32_32x32x16_bf16 v[128:143], a[4:7], v[228:231], v[128:143]
    ds_read_b128 v[224:227], v254 offset:6144
    buffer_load_dwordx4 v2, s[60:63], s81 offen offset:3072 sc1 lds
    v_mfma_f32_32x32x16_bf16 v[144:159], a[116:119], v[228:231], v[144:159]
    s_waitcnt lgkmcnt(3)
    v_mfma_f32_32x32x16_bf16 v[128:143], a[8:11], v[232:235], v[128:143]
    ds_read_b128 v[228:231], v254 offset:7168
    s_add_u32 m0, s87, 102400
    s_add_u32 s81, s76, 32768
    v_mfma_f32_32x32x16_bf16 v[144:159], a[120:123], v[232:235], v[144:159]
    buffer_load_dwordx4 v2, s[60:63], s81 offen offset:0 sc1 lds
    v_mfma_f32_32x32x16_bf16 v[128:143], a[12:15], v[236:239], v[128:143]
    s_waitcnt vmcnt(7)
    s_barrier
    ds_read_b128 v[232:235], v254 offset:8192
    buffer_load_dwordx4 v2, s[60:63], s81 offen offset:1024 sc1 lds
    v_mfma_f32_32x32x16_bf16 v[144:159], a[124:127], v[236:239], v[144:159]
    s_waitcnt lgkmcnt(3)
    ds_read_b64_tr_b16 a[80:81], v124 offset:0
    ds_read_b64_tr_b16 a[82:83], v124 offset:1024
    ds_read_b64_tr_b16 a[192:193], v125 offset:0
    ds_read_b64_tr_b16 a[194:195], v125 offset:1024
    v_mfma_f32_32x32x16_bf16 v[128:143], a[16:19], v[240:243], v[128:143]
    s_waitcnt vmcnt(6)
    ds_read_b128 v[236:239], v254 offset:9216
    buffer_load_dwordx4 v2, s[60:63], s81 offen offset:2048 sc1 lds
    ds_read_b64_tr_b16 a[84:85], v124 offset:2048
    ds_read_b64_tr_b16 a[86:87], v124 offset:3072
Lc_32:
    v_cmp_ne_u32 vcc, s64, v179
    s_cbranch_vccnz Lr_33
Lk_34:
    v_mfma_f32_32x32x16_bf16 v[144:159], a[128:131], v[240:243], v[144:159]
    ds_read_b64_tr_b16 a[196:197], v125 offset:2048
    ds_read_b64_tr_b16 a[198:199], v125 offset:3072
    ds_read_b64_tr_b16 a[88:89], v124 offset:4096
    ds_read_b64_tr_b16 a[90:91], v124 offset:5120
    v_mfma_f32_32x32x16_bf16 v[128:143], a[20:23], v[244:247], v[128:143]
    ds_read_b128 v[240:243], v254 offset:10240
    ds_read_b64_tr_b16 a[200:201], v125 offset:4096
    ds_read_b64_tr_b16 a[202:203], v125 offset:5120
    s_mov_b32 m0, s8
    v_mfma_f32_32x32x16_bf16 v[144:159], a[132:135], v[244:247], v[144:159]
    s_waitcnt lgkmcnt(15)
    buffer_load_dword v177, s[60:63], s9 offen sc1 lds
    ds_read_b64_tr_b16 a[92:93], v124 offset:6144
    ds_read_b64_tr_b16 a[94:95], v124 offset:7168
    ds_read_b64_tr_b16 a[204:205], v125 offset:6144
    ds_read_b64_tr_b16 a[206:207], v125 offset:7168
    v_mfma_f32_32x32x16_bf16 v[128:143], a[24:27], v[224:227], v[128:143]
    ds_read_b128 v[244:247], v254 offset:11264
    ds_read_b64_tr_b16 a[96:97], v124 offset:8192
    ds_read_b64_tr_b16 a[98:99], v124 offset:9216
    s_add_u32 m0, s90, 4096
    s_add_u32 s81, s77, 0
    v_mfma_f32_32x32x16_bf16 v[144:159], a[136:139], v[224:227], v[144:159]
    buffer_load_dwordx4 v2, s[60:63], s81 offen offset:0 sc1 lds
    ds_read_b64_tr_b16 a[208:209], v125 offset:8192
    ds_read_b64_tr_b16 a[210:211], v125 offset:9216
    ds_read_b64_tr_b16 a[100:101], v124 offset:10240
    ds_read_b64_tr_b16 a[102:103], v124 offset:11264
    v_mfma_f32_32x32x16_bf16 v[128:143], a[28:31], v[228:231], v[128:143]
    ds_read_b128 v[224:227], v254 offset:12288
    buffer_load_dwordx4 v2, s[60:63], s81 offen offset:1024 sc1 lds
    ds_read_b64_tr_b16 a[212:213], v125 offset:10240
    ds_read_b64_tr_b16 a[214:215], v125 offset:11264
    v_mfma_f32_32x32x16_bf16 v[144:159], a[140:143], v[228:231], v[144:159]
    s_waitcnt lgkmcnt(15)
    ds_read_b64_tr_b16 a[104:105], v124 offset:12288
    ds_read_b64_tr_b16 a[106:107], v124 offset:13312
    ds_read_b64_tr_b16 a[216:217], v125 offset:12288
    ds_read_b64_tr_b16 a[218:219], v125 offset:13312
    v_mfma_f32_32x32x16_bf16 v[128:143], a[32:35], v[232:235], v[128:143]
    ds_read_b128 v[228:231], v254 offset:13312
    buffer_load_dwordx4 v2, s[60:63], s81 offen offset:2048 sc1 lds
    ds_read_b64_tr_b16 a[108:109], v124 offset:14336
    ds_read_b64_tr_b16 a[110:111], v124 offset:15360
    v_mfma_f32_32x32x16_bf16 v[144:159], a[144:147], v[232:235], v[144:159]
    ds_read_b64_tr_b16 a[220:221], v125 offset:14336
    ds_read_b64_tr_b16 a[222:223], v125 offset:15360
    v_mfma_f32_32x32x16_bf16 v[128:143], a[36:39], v[236:239], v[128:143]
    ds_read_b128 v[232:235], v254 offset:14336
    buffer_load_dwordx4 v2, s[60:63], s81 offen offset:3072 sc1 lds
    v_mfma_f32_32x32x16_bf16 v[144:159], a[148:151], v[236:239], v[144:159]
    s_waitcnt lgkmcnt(15)
    v_mfma_f32_32x32x16_bf16 v[128:143], a[40:43], v[240:243], v[128:143]
    ds_read_b128 v[236:239], v254 offset:15360
    s_add_u32 m0, s90, 0
    s_add_u32 s81, s91, 0
    v_mfma_f32_32x32x16_bf16 v[144:159], a[152:155], v[240:243], v[144:159]
    buffer_load_dwordx4 v1, s[52:55], s81 offen offset:0  lds
    v_mfma_f32_32x32x16_bf16 v[128:143], a[44:47], v[244:247], v[128:143]
    s_waitcnt lgkmcnt(2)
    s_barrier
    ds_read_b128 v[240:243], v254 offset:16384
    buffer_load_dwordx4 v4, s[52:55], s81 offen offset:1024  lds
    v_mfma_f32_32x32x16_bf16 v[144:159], a[156:159], v[244:247], v[144:159]
    v_mfma_f32_32x32x16_bf16 v[128:143], a[48:51], v[224:227], v[128:143]
    ds_read_b128 v[244:247], v254 offset:17408
    buffer_load_dwordx4 v5, s[52:55], s81 offen offset:2048  lds
    v_mfma_f32_32x32x16_bf16 v[144:159], a[160:163], v[224:227], v[144:159]
    v_mfma_f32_32x32x16_bf16 v[128:143], a[52:55], v[228:231], v[128:143]
    ds_read_b128 v[224:227], v254 offset:18432
    v_mfma_f32_32x32x16_bf16 v[144:159], a[164:167], v[228:231], v[144:159]
    s_waitcnt lgkmcnt(3) vmcnt(8)
    ds_read_b128 v[16:19], v255 offset:32768
    buffer_load_dwordx4 v6, s[52:55], s81 offen offset:3072  lds
    v_mfma_f32_32x32x16_bf16 v[128:143], a[56:59], v[232:235], v[128:143]
    ds_read_b128 v[228:231], v254 offset:19456
    v_mfma_f32_32x32x16_bf16 v[144:159], a[168:171], v[232:235], v[144:159]
    ds_read_b128 v[20:23], v255 offset:33792
    s_add_u32 m0, s16, 0
    s_add_u32 s81, s91, 57344
    v_mfma_f32_32x32x16_bf16 v[128:143], a[60:63], v[236:239], v[128:143]
    ds_read_b128 v[232:235], v254 offset:20480
    buffer_load_dwordx4 v1, s[52:55], s81 offen offset:0  lds
    v_mfma_f32_32x32x16_bf16 v[144:159], a[172:175], v[236:239], v[144:159]
    s_waitcnt lgkmcnt(5)
    ds_read_b128 v[24:27], v255 offset:34816
    buffer_load_dwordx4 v4, s[52:55], s81 offen offset:1024  lds
    v_mfma_f32_32x32x16_bf16 v[128:143], a[64:67], v[240:243], v[128:143]
    s_waitcnt vmcnt(6)
    ds_read_b128 v[236:239], v254 offset:21504
    ds_read2st64_b32 v[160:161], v112 offset0:0 offset1:1
    v_mfma_f32_32x32x16_bf16 v[144:159], a[176:179], v[240:243], v[144:159]
    ds_read_b128 v[28:31], v255 offset:35840
    ds_read2st64_b32 v[162:163], v112 offset0:2 offset1:3
    v_mfma_f32_32x32x16_bf16 v[128:143], a[68:71], v[244:247], v[128:143]
    ds_read_b128 v[240:243], v254 offset:22528
    buffer_load_dwordx4 v5, s[52:55], s81 offen offset:2048  lds
    ds_read2st64_b32 v[164:165], v112 offset0:4 offset1:5
    v_mfma_f32_32x32x16_bf16 v[144:159], a[180:183], v[244:247], v[144:159]
    s_waitcnt lgkmcnt(9)
    ds_read_b128 v[32:35], v255 offset:36864
    ds_read2st64_b32 v[166:167], v112 offset0:6 offset1:7
    v_mfma_f32_32x32x16_bf16 v[128:143], a[72:75], v[224:227], v[128:143]
    ds_read_b128 v[244:247], v254 offset:23552
    buffer_load_dwordx4 v6, s[52:55], s81 offen offset:3072  lds
    ds_read2st64_b32 v[168:169], v112 offset0:8 offset1:9
    v_mfma_f32_32x32x16_bf16 v[144:159], a[184:187], v[224:227], v[144:159]
    ds_read_b128 v[36:39], v255 offset:37888
    ds_read2st64_b32 v[170:171], v112 offset0:10 offset1:11
    v_mfma_f32_32x32x16_bf16 v[128:143], a[76:79], v[228:231], v[128:143]
    ds_read_b128 v[224:227], v254 offset:24576
    ds_read2st64_b32 v[172:173], v112 offset0:12 offset1:13
    v_mfma_f32_32x32x16_bf16 v[144:159], a[188:191], v[228:231], v[144:159]
    s_waitcnt lgkmcnt(13)
    ds_read_b128 v[40:43], v255 offset:38912
    s_add_u32 m0, s16, 4096
    s_add_u32 s81, s91, 114688
    s_waitcnt lgkmcnt(1)
    v_max3_u32 v252, v160, v161, v162
    v_max3_u32 v252, v252, v163, v164
    v_mfma_f32_32x32x16_bf16 v[128:143], a[80:83], v[232:235], v[128:143]
    ds_read_b128 v[228:231], v254 offset:25600
    buffer_load_dwordx4 v1, s[52:55], s81 offen offset:0  lds
    v_max3_u32 v252, v252, v165, v166
    v_max3_u32 v252, v252, v167, v168
    v_max3_u32 v252, v252, v169, v170
    v_max3_u32 v252, v252, v171, v172
    v_mfma_f32_32x32x16_bf16 v[144:159], a[192:195], v[232:235], v[144:159]
    buffer_load_dwordx4 v4, s[52:55], s81 offen offset:1024  lds
    v_max_u32 v252, v252, v173
    v_cmp_eq_u32 vcc, -1, v252
    v_mfma_f32_32x32x16_bf16 v[128:143], a[84:87], v[236:239], v[128:143]
    ds_read_b128 v[232:235], v254 offset:26624
Lc_38:
    s_cbranch_vccnz Lr_39
Lk_40:
    v_add_f32 v160, v160, v161
    v_add_f32 v160, v160, v162
    v_add_f32 v160, v160, v163
    v_add_f32_e64 v160, v160, v164
    v_mfma_f32_32x32x16_bf16 v[144:159], a[196:199], v[236:239], v[144:159]
    s_waitcnt lgkmcnt(2)
    buffer_load_dwordx4 v5, s[52:55], s81 offen offset:2048  lds
    v_max3_u32 v111, v16, v20, v24
    v_max3_u32 v111, v111, v28, v32
    v_max3_u32 v111, v111, v36, v40
    v_cmp_eq_u32 vcc, -1, v111
    v_mfma_f32_32x32x16_bf16 v[128:143], a[88:91], v[240:243], v[128:143]
    ds_read_b128 v[236:239], v254 offset:27648
    ds_read_b128 v[192:195], v178 offset:0
    v_add_f32 v160, v160, v165
    v_add_f32 v160, v160, v166
    v_add_f32 v160, v160, v167
    v_add_f32 v160, v160, v168
    v_mfma_f32_32x32x16_bf16 v[144:159], a[200:203], v[240:243], v[144:159]
    ds_read_b128 v[196:199], v178 offset:32
    ds_read_b128 v[200:203], v178 offset:128
Lc_35:
    s_cbranch_vccnz Lr_36
Lk_37:
    s_barrier
    v_add_f32 v160, v160, v169
    v_mfma_f32_32x32x16_bf16 v[128:143], a[92:95], v[244:247], v[128:143]
    ds_read_b128 v[240:243], v254 offset:32768
    buffer_load_dwordx4 v6, s[52:55], s81 offen offset:3072  lds
    ds_read_b128 v[204:207], v178 offset:160
    v_add_f32 v160, v160, v170
    v_add_f32 v160, v160, v171
    v_add_f32 v160, v160, v172
    v_mfma_f32_32x32x16_bf16 v[144:159], a[204:207], v[244:247], v[144:159]
    s_waitcnt lgkmcnt(7)
    ds_read_b128 v[208:211], v178 offset:64
    ds_read_b128 v[212:215], v178 offset:96
    v_add_f32 v160, v160, v173
    v_mul_f32 v160, 991054117, v160
    v_mov_b32_e64 v161, v160
    s_lshl_b32 s22, s3, 9
    v_mfma_f32_32x32x16_bf16 v[128:143], a[96:99], v[224:227], v[128:143]
    ds_read_b128 v[244:247], v254 offset:33792
    ds_read_b128 v[216:219], v178 offset:192
    s_add_u32 m0, s16, 8192
    s_add_u32 s81, s91, 172032
    v_add_u32 v253, s22, v9
    v_mfma_f32_32x32x16_bf16 v[144:159], a[208:211], v[224:227], v[144:159]
    buffer_load_dwordx4 v1, s[52:55], s81 offen offset:0  lds
    ds_read_b128 v[220:223], v178 offset:224
    v_permlane32_swap_b32 v160, v161
    v_fma_f32 v162, -v160, v160, v161
    v_max_f32 v162, 0, v162
L_pb1:
    s_cbranch_execz L_wr_r
    v_mfma_f32_32x32x16_bf16 v[128:143], a[100:103], v[228:231], v[128:143]
    ds_read_b128 v[224:227], v254 offset:34816
    v_add_f32 v162, 0x3727c5ac, v162
    v_rsq_f32 v161, v162
    v_mul_f32_e64 v160, -1.0, v160
    v_mul_f32_e64 v161, v161, -s70
    v_mfma_f32_32x32x16_bf16 v[144:159], a[212:215], v[228:231], v[144:159]
    s_waitcnt lgkmcnt(11)
    buffer_load_dwordx4 v4, s[52:55], s81 offen offset:1024  lds
    ds_write_b128 v253, v[160:163]
    v_mfma_f32_32x32x16_bf16 v[128:143], a[104:107], v[232:235], v[128:143]
    ds_read_b128 v[228:231], v254 offset:35840
    v_mfma_f32_32x32x16_bf16 v[144:159], a[216:219], v[232:235], v[144:159]
    buffer_load_dwordx4 v5, s[52:55], s81 offen offset:2048  lds
    v_mfma_f32_32x32x16_bf16 v[128:143], a[108:111], v[236:239], v[128:143]
    ds_read_b128 v[232:235], v254 offset:36864
    v_mfma_f32_32x32x16_bf16 v[144:159], a[220:223], v[236:239], v[144:159]
    s_waitcnt lgkmcnt(6)
    s_waitcnt lgkmcnt(2)
    s_barrier
    buffer_load_dwordx4 v6, s[52:55], s81 offen offset:3072  lds
    v_mfma_f32_32x32x16_bf16 v[160:175], a[0:3], v[240:243], 0
    ds_read_b128 v[236:239], v254 offset:37888
    ds_read_b128 v[248:251], v9 offset:0
    v_mfma_f32_32x32x16_bf16 v[176:191], a[112:115], v[240:243], 0
    v_mfma_f32_32x32x16_bf16 v[160:175], a[4:7], v[244:247], v[160:175]
    ds_read_b128 v[240:243], v254 offset:38912
    s_add_u32 m0, s87, 65536
    s_add_u32 s81, s76, 57344
    v_mfma_f32_32x32x16_bf16 v[176:191], a[116:119], v[244:247], v[176:191]
    s_waitcnt lgkmcnt(4)
    buffer_load_dwordx4 v2, s[60:63], s81 offen offset:0 sc1 lds
    s_waitcnt lgkmcnt(1)
    v_fmac_f32 v128, v248, v192
    v_fmac_f32 v129, v248, v193
    v_fmac_f32 v130, v248, v194
    v_mfma_f32_32x32x16_bf16 v[160:175], a[8:11], v[224:227], v[160:175]
    ds_read_b128 v[244:247], v254 offset:39936
    buffer_load_dwordx4 v2, s[60:63], s81 offen offset:1024 sc1 lds
    v_fmac_f32 v131, v248, v195
    v_mul_f32 v124, v249, v128
    v_mul_f32 v125, v249, v129
    v_mul_f32 v126, v249, v130
    v_mfma_f32_32x32x16_bf16 v[176:191], a[120:123], v[224:227], v[176:191]
    v_mul_f32 v127, v249, v131
    v_exp_f32 v124, v124
    v_fmac_f32 v136, v248, v200
    v_exp_f32 v125, v125
    v_mfma_f32_32x32x16_bf16 v[160:175], a[12:15], v[228:231], v[160:175]
    ds_read_b128 v[224:227], v254 offset:40960
    buffer_load_dwordx4 v2, s[60:63], s81 offen offset:2048 sc1 lds
    v_fmac_f32 v137, v248, v201
    v_exp_f32 v126, v126
    v_fmac_f32 v138, v248, v202
    v_mfma_f32_32x32x16_bf16 v[176:191], a[124:127], v[228:231], v[176:191]
    v_exp_f32 v127, v127
    v_fmac_f32_e64 v139, v248, v203
    v_fma_f32 v124, v124, v250, v250
    v_fma_f32 v125, v125, v250, v250
    v_fma_f32 v126, v126, v250, v250
    v_mfma_f32_32x32x16_bf16 v[160:175], a[16:19], v[232:235], v[160:175]
    ds_read_b128 v[228:231], v254 offset:41984
    buffer_load_dwordx4 v2, s[60:63], s81 offen offset:3072 sc1 lds
    v_fma_f32 v127, v127, v250, v250
    v_rcp_f32 v124, v124
    v_mul_f32 v128, v128, v136
    v_mfma_f32_32x32x16_bf16 v[176:191], a[128:131], v[232:235], v[176:191]
    v_rcp_f32 v125, v125
    v_mul_f32 v129, v129, v137
    v_rcp_f32 v126, v126
    v_mul_f32 v130, v130, v138
    v_mfma_f32_32x32x16_bf16 v[160:175], a[20:23], v[236:239], v[160:175]
    ds_read_b128 v[232:235], v254 offset:43008
    s_add_u32 m0, s87, 69632
    s_add_u32 s81, s76, 61440
    v_rcp_f32 v127, v127
    v_mul_f32 v131, v131, v139
    v_mfma_f32_32x32x16_bf16 v[176:191], a[132:135], v[236:239], v[176:191]
    s_waitcnt lgkmcnt(3)
    buffer_load_dwordx4 v2, s[60:63], s81 offen offset:0 sc1 lds
    v_mul_f32 v128, v128, v124
    v_mul_f32 v129, v129, v125
    v_mul_f32 v130, v130, v126
    v_mul_f32 v131, v131, v127
    s_add_u32 s22, s78, 0
    v_mfma_f32_32x32x16_bf16 v[160:175], a[24:27], v[240:243], v[160:175]
    ds_read_b128 v[236:239], v254 offset:44032
    buffer_load_dwordx4 v2, s[60:63], s81 offen offset:1024 sc1 lds
    v_cvt_pk_bf16_f32 v116, v128, v129
    v_cvt_pk_bf16_f32 v117, v130, v131
    v_fmac_f32 v132, v248, v196
    v_fmac_f32 v133, v248, v197
    v_mfma_f32_32x32x16_bf16 v[176:191], a[136:139], v[240:243], v[176:191]
    v_fmac_f32 v134, v248, v198
    v_fmac_f32 v135, v248, v199
    v_mul_f32 v124, v249, v132
    v_mul_f32 v125, v249, v133
    v_mul_f32 v126, v249, v134
    v_mul_f32 v127, v249, v135
    v_mfma_f32_32x32x16_bf16 v[160:175], a[28:31], v[244:247], v[160:175]
    ds_read_b128 v[240:243], v254 offset:45056
    buffer_load_dwordx4 v2, s[60:63], s81 offen offset:2048 sc1 lds
    v_exp_f32 v124, v124
    v_fmac_f32 v140, v248, v204
    v_mfma_f32_32x32x16_bf16 v[176:191], a[140:143], v[244:247], v[176:191]
    s_waitcnt lgkmcnt(3)
    v_exp_f32 v125, v125
    v_fmac_f32 v141, v248, v205
    v_exp_f32 v126, v126
    v_fmac_f32_e64 v142, v248, v206
    v_mfma_f32_32x32x16_bf16 v[160:175], a[32:35], v[224:227], v[160:175]
    ds_read_b128 v[244:247], v254 offset:46080
    s_add_u32 m0, s16, 12288
    s_add_u32 s81, s91, 229376
    v_exp_f32 v127, v127
    v_fmac_f32 v143, v248, v207
    v_mfma_f32_32x32x16_bf16 v[176:191], a[144:147], v[224:227], v[176:191]
    buffer_load_dwordx4 v1, s[52:55], s81 offen offset:0  lds
    v_fma_f32 v124, v124, v250, v250
    v_fma_f32 v125, v125, v250, v250
    v_fma_f32 v126, v126, v250, v250
    v_fma_f32 v127, v127, v250, v250
    v_mfma_f32_32x32x16_bf16 v[160:175], a[36:39], v[228:231], v[160:175]
    ds_read_b128 v[224:227], v254 offset:47104
    buffer_load_dwordx4 v4, s[52:55], s81 offen offset:1024  lds
    v_rcp_f32 v124, v124
    v_mul_f32 v132, v132, v140
    v_mfma_f32_32x32x16_bf16 v[176:191], a[148:151], v[228:231], v[176:191]
    s_waitcnt lgkmcnt(3)
    v_rcp_f32 v125, v125
    v_mul_f32 v133, v133, v141
    v_rcp_f32 v126, v126
    v_mul_f32 v134, v134, v142
    v_mfma_f32_32x32x16_bf16 v[160:175], a[40:43], v[232:235], v[160:175]
    s_waitcnt vmcnt(21)
    ds_read_b128 v[228:231], v254 offset:48128
    ds_read_b64_tr_b16 v[16:17], v10 offset:0
    ds_read_b64_tr_b16 v[18:19], v10 offset:1024
    v_rcp_f32 v127, v127
    v_mul_f32 v135, v135, v143
    v_mfma_f32_32x32x16_bf16 v[176:191], a[152:155], v[232:235], v[176:191]
    buffer_load_dwordx4 v5, s[52:55], s81 offen offset:2048  lds
    ds_read_b64_tr_b16 v[20:21], v11 offset:0
    ds_read_b64_tr_b16 v[22:23], v11 offset:1024
    ds_read_b64_tr_b16 v[24:25], v113 offset:0
    ds_read_b64_tr_b16 v[26:27], v113 offset:1024
    v_mul_f32_e64 v132, v132, v124
    v_mfma_f32_32x32x16_bf16 v[160:175], a[44:47], v[236:239], v[160:175]
    ds_read_b128 v[232:235], v254 offset:49152
    ds_read_b64_tr_b16 v[28:29], v114 offset:0
    ds_read_b64_tr_b16 v[30:31], v114 offset:1024
    v_mul_f32 v133, v133, v125
    v_mul_f32 v134, v134, v126
    v_mul_f32 v135, v135, v127
    v_mfma_f32_32x32x16_bf16 v[176:191], a[156:159], v[236:239], v[176:191]
    s_waitcnt lgkmcnt(11)
    buffer_load_dwordx4 v6, s[52:55], s81 offen offset:3072  lds
    v_cvt_pk_bf16_f32 v118, v132, v133
    v_cvt_pk_bf16_f32 v119, v134, v135
    v_mfma_f32_32x32x16_bf16 v[160:175], a[48:51], v[240:243], v[160:175]
    ds_read_b128 v[236:239], v254 offset:50176
    buffer_store_dwordx4 v[116:119], v2, s[60:63], s22 offen sc1
    v_fmac_f32 v144, v248, v208
    v_fmac_f32 v145, v248, v209
    v_fmac_f32 v146, v248, v210
    v_fmac_f32 v147, v248, v211
    v_mfma_f32_32x32x16_bf16 v[176:191], a[160:163], v[240:243], v[176:191]
    v_mul_f32 v124, v249, v144
    v_mul_f32 v125, v249, v145
    v_mul_f32 v126, v249, v146
    v_mul_f32 v127, v249, v147
    v_exp_f32_e64 v124, v124
    v_mfma_f32_32x32x16_bf16 v[160:175], a[52:55], v[244:247], v[160:175]
    ds_read_b128 v[240:243], v254 offset:51200
    s_add_u32 m0, s90, 4096
    s_add_u32 s81, s91, 286720
    v_fmac_f32 v152, v248, v216
    v_exp_f32 v125, v125
    v_mfma_f32_32x32x16_bf16 v[176:191], a[164:167], v[244:247], v[176:191]
    s_waitcnt lgkmcnt(11)
    buffer_load_dwordx4 v1, s[52:55], s81 offen offset:0  lds
    v_fmac_f32 v153, v248, v217
    v_exp_f32 v126, v126
    v_fmac_f32 v154, v248, v218
    v_mfma_f32_32x32x16_bf16 v[160:175], a[56:59], v[224:227], v[160:175]
    ds_read_b128 v[244:247], v254 offset:52224
    buffer_load_dwordx4 v4, s[52:55], s81 offen offset:1024  lds
    v_exp_f32 v127, v127
    v_fmac_f32 v155, v248, v219
    v_fma_f32 v124, v124, v250, v250
    v_mfma_f32_32x32x16_bf16 v[176:191], a[168:171], v[224:227], v[176:191]
    v_fma_f32 v125, v125, v250, v250
    v_fma_f32 v126, v126, v250, v250
    v_fma_f32 v127, v127, v250, v250
    v_rcp_f32 v124, v124
    v_mul_f32 v144, v144, v152
    v_mfma_f32_32x32x16_bf16 v[160:175], a[60:63], v[228:231], v[160:175]
    ds_read_b128 v[224:227], v254 offset:53248
    buffer_load_dwordx4 v5, s[52:55], s81 offen offset:2048  lds
    v_rcp_f32 v125, v125
    v_mul_f32 v145, v145, v153
    v_subrev_u32 v10, s92, v10
    v_mfma_f32_32x32x16_bf16 v[176:191], a[172:175], v[228:231], v[176:191]
    s_waitcnt lgkmcnt(3)
    v_rcp_f32 v126, v126
    v_mul_f32 v146, v146, v154
    v_rcp_f32 v127, v127
    v_mul_f32 v147, v147, v155
    v_mfma_f32_32x32x16_bf16 v[160:175], a[64:67], v[232:235], v[160:175]
    ds_read_b128 v[228:231], v254 offset:54272
    v_mul_f32 v144, v144, v124
    v_mul_f32 v145, v145, v125
    v_mul_f32 v146, v146, v126
    v_mul_f32 v147, v147, v127
    s_add_u32 s6, s78, 57344
    v_mfma_f32_32x32x16_bf16 v[176:191], a[176:179], v[232:235], v[176:191]
    buffer_load_dwordx4 v6, s[52:55], s81 offen offset:3072  lds
    v_cvt_pk_bf16_f32 v120, v144, v145
    v_cvt_pk_bf16_f32 v121, v146, v147
    v_fmac_f32 v148, v248, v212
    v_fmac_f32 v149, v248, v213
    v_fmac_f32 v150, v248, v214
    v_mfma_f32_32x32x16_bf16 v[160:175], a[68:71], v[236:239], v[160:175]
    ds_read_b128 v[232:235], v254 offset:55296
    v_fmac_f32 v151, v248, v215
    v_mul_f32 v124, v249, v148
    v_mul_f32 v125, v249, v149
    v_mul_f32 v126, v249, v150
    v_mul_f32 v127, v249, v151
    v_mfma_f32_32x32x16_bf16 v[176:191], a[180:183], v[236:239], v[176:191]
    s_waitcnt lgkmcnt(3)
    s_add_u32 m0, s90, 0
    s_add_u32 s81, s91, 344064
    v_exp_f32 v124, v124
    v_fmac_f32 v156, v248, v220
    v_mfma_f32_32x32x16_bf16 v[160:175], a[72:75], v[240:243], v[160:175]
    ds_read_b128 v[236:239], v254 offset:56320
    buffer_load_dwordx4 v1, s[52:55], s81 offen offset:0  lds
    v_exp_f32 v125, v125
    v_fmac_f32 v157, v248, v221
    v_subrev_u32 v11, s92, v11
    v_mfma_f32_32x32x16_bf16 v[176:191], a[184:187], v[240:243], v[176:191]
    v_exp_f32 v126, v126
    v_fmac_f32 v158, v248, v222
    v_exp_f32 v127, v127
    v_fmac_f32_e64 v159, v248, v223
    v_mfma_f32_32x32x16_bf16 v[160:175], a[76:79], v[244:247], v[160:175]
    ds_read_b128 v[240:243], v254 offset:57344
    buffer_load_dwordx4 v4, s[52:55], s81 offen offset:1024  lds
    v_fma_f32 v124, v124, v250, v250
    v_fma_f32 v125, v125, v250, v250
    v_fma_f32 v126, v126, v250, v250
    v_fma_f32 v127, v127, v250, v250
    v_mfma_f32_32x32x16_bf16 v[176:191], a[188:191], v[244:247], v[176:191]
    s_waitcnt lgkmcnt(3)
    v_rcp_f32 v124, v124
    v_mul_f32 v148, v148, v156
    v_rcp_f32 v125, v125
    v_mul_f32 v149, v149, v157
    v_mfma_f32_32x32x16_bf16 v[160:175], a[80:83], v[224:227], v[160:175]
    ds_read_b128 v[244:247], v254 offset:58368
    buffer_load_dwordx4 v5, s[52:55], s81 offen offset:2048  lds
    v_rcp_f32 v126, v126
    v_mul_f32 v150, v150, v158
    v_subrev_u32 v113, s92, v113
    v_mfma_f32_32x32x16_bf16 v[176:191], a[192:195], v[224:227], v[176:191]
    v_rcp_f32 v127, v127
    v_mul_f32 v151, v151, v159
    v_mul_f32 v148, v148, v124
    v_mul_f32 v149, v149, v125
    v_mul_f32 v150, v150, v126
    v_mfma_f32_32x32x16_bf16 v[160:175], a[84:87], v[228:231], v[160:175]
    ds_read_b128 v[224:227], v254 offset:59392
    buffer_load_dwordx4 v6, s[52:55], s81 offen offset:3072  lds
    v_mul_f32_e64 v151, v151, v127
    v_cvt_pk_bf16_f32 v122, v148, v149
    v_cvt_pk_bf16_f32 v123, v150, v151
    v_subrev_u32 v114, s92, v114
    v_mfma_f32_32x32x16_bf16 v[176:191], a[196:199], v[228:231], v[176:191]
    s_waitcnt lgkmcnt(3)
    buffer_store_dwordx4 v[120:123], v2, s[60:63], s6 offen sc1
    s_waitcnt vmcnt(29)
    v_mfma_f32_32x32x16_bf16 v[160:175], a[88:91], v[232:235], v[160:175]
    ds_read_b128 v[228:231], v254 offset:60416
    ds_read_b64_tr_b16 v[32:33], v10 offset:0
    ds_read_b64_tr_b16 v[34:35], v10 offset:1024
    v_mfma_f32_32x32x16_bf16 v[176:191], a[200:203], v[232:235], v[176:191]
    s_waitcnt vmcnt(14)
    s_barrier
    ds_read_b64_tr_b16 v[36:37], v11 offset:0
    ds_read_b64_tr_b16 v[38:39], v11 offset:1024
    ds_read_b64_tr_b16 v[40:41], v113 offset:0
    ds_read_b64_tr_b16 v[42:43], v113 offset:1024
    v_mfma_f32_32x32x16_bf16 v[160:175], a[92:95], v[236:239], v[160:175]
    ds_read_b128 v[232:235], v254 offset:0
    ds_read_b64_tr_b16 v[44:45], v114 offset:0
    ds_read_b64_tr_b16 v[46:47], v114 offset:1024
    s_waitcnt lgkmcnt(0)
    s_add_u32 m0, s16, 0
    s_add_u32 s81, s91, 14336
    v_mfma_f32_32x32x16_bf16 v[176:191], a[204:207], v[236:239], v[176:191]
    buffer_load_dwordx4 v1, s[52:55], s81 offen offset:0  lds
    v_mfma_f32_32x32x16_bf16 v[160:175], a[96:99], v[240:243], v[160:175]
    ds_read_b128 v[236:239], v254 offset:1024
    buffer_load_dwordx4 v4, s[52:55], s81 offen offset:1024  lds
    ds_read_b64_tr_b16 v[48:49], v10 offset:4096
    ds_read_b64_tr_b16 v[50:51], v10 offset:5120
    v_mfma_f32_32x32x16_bf16 v[176:191], a[208:211], v[240:243], v[176:191]
    ds_read_b64_tr_b16 v[52:53], v11 offset:4096
    ds_read_b64_tr_b16 v[54:55], v11 offset:5120
    ds_read_b64_tr_b16 v[56:57], v113 offset:4096
    ds_read_b64_tr_b16 v[58:59], v113 offset:5120
    v_mfma_f32_32x32x16_bf16 v[160:175], a[100:103], v[244:247], v[160:175]
    ds_read_b128 v[240:243], v254 offset:2048
    buffer_load_dwordx4 v5, s[52:55], s81 offen offset:2048  lds
    ds_read_b64_tr_b16 v[60:61], v114 offset:4096
    ds_read_b64_tr_b16 v[62:63], v114 offset:5120
    v_mfma_f32_32x32x16_bf16 v[176:191], a[212:215], v[244:247], v[176:191]
    ds_read_b64_tr_b16 v[64:65], v10 offset:8192
    ds_read_b64_tr_b16 v[66:67], v10 offset:9216
    ds_read_b64_tr_b16 v[68:69], v11 offset:8192
    ds_read_b64_tr_b16 v[70:71], v11 offset:9216
    v_mfma_f32_32x32x16_bf16 v[160:175], a[104:107], v[224:227], v[160:175]
    ds_read_b128 v[244:247], v254 offset:3072
    buffer_load_dwordx4 v6, s[52:55], s81 offen offset:3072  lds
    ds_read_b64_tr_b16 v[72:73], v113 offset:8192
    ds_read_b64_tr_b16 v[74:75], v113 offset:9216
    v_mfma_f32_32x32x16_bf16 v[176:191], a[216:219], v[224:227], v[176:191]
    ds_read_b64_tr_b16 v[76:77], v114 offset:8192
    ds_read_b64_tr_b16 v[78:79], v114 offset:9216
    v_mfma_f32_32x32x16_bf16 v[160:175], a[108:111], v[228:231], v[160:175]
    ds_read_b128 v[224:227], v254 offset:4096
La_46:
    s_mov_b64 exec, 65535
    buffer_load_dword v12, v115, s[60:63], s14 offen sc1
    s_mov_b64 exec, -1
Lb_47:
    v_mfma_f32_32x32x16_bf16 v[176:191], a[220:223], v[228:231], v[176:191]
    s_waitcnt lgkmcnt(15)
    s_barrier
    v_mfma_f32_32x32x16_bf16 v[128:143], a[0:3], v[232:235], 0
    ds_read_b128 v[228:231], v254 offset:5120
    ds_read_b128 v[248:251], v9 offset:512
    v_mfma_f32_32x32x16_bf16 v[144:159], a[112:115], v[232:235], 0
    s_add_u32 m0, s87, 98304
    s_add_u32 s81, s76, 86016
    v_mfma_f32_32x32x16_bf16 v[128:143], a[4:7], v[236:239], v[128:143]
    ds_read_b128 v[232:235], v254 offset:6144
    buffer_load_dwordx4 v2, s[60:63], s81 offen offset:0 sc1 lds
    v_mfma_f32_32x32x16_bf16 v[144:159], a[116:119], v[236:239], v[144:159]
    s_waitcnt lgkmcnt(8)
    buffer_load_dwordx4 v2, s[60:63], s81 offen offset:1024 sc1 lds
    s_waitcnt lgkmcnt(1)
    v_fmac_f32 v160, v248, v192
    v_fmac_f32 v161, v248, v193
    v_fmac_f32 v162, v248, v194
    v_fmac_f32 v163, v248, v195
    v_mfma_f32_32x32x16_bf16 v[128:143], a[8:11], v[240:243], v[128:143]
    ds_read_b128 v[236:239], v254 offset:7168
    v_mul_f32 v124, v249, v160
    v_mul_f32 v125, v249, v161
    v_mul_f32 v126, v249, v162
    v_mul_f32 v127, v249, v163
    v_mfma_f32_32x32x16_bf16 v[144:159], a[120:123], v[240:243], v[144:159]
    buffer_load_dwordx4 v2, s[60:63], s81 offen offset:2048 sc1 lds
    v_exp_f32 v124, v124
    v_fmac_f32 v168, v248, v200
    v_exp_f32 v125, v125
    v_mfma_f32_32x32x16_bf16 v[128:143], a[12:15], v[244:247], v[128:143]
    ds_read_b128 v[240:243], v254 offset:8192
    v_fmac_f32 v169, v248, v201
    v_exp_f32 v126, v126
    v_fmac_f32 v170, v248, v202
    v_mfma_f32_32x32x16_bf16 v[144:159], a[124:127], v[244:247], v[144:159]
    buffer_load_dwordx4 v2, s[60:63], s81 offen offset:3072 sc1 lds
    v_exp_f32 v127, v127
    v_fmac_f32_e64 v171, v248, v203
    v_fma_f32 v124, v124, v250, v250
    v_fma_f32 v125, v125, v250, v250
    v_mfma_f32_32x32x16_bf16 v[128:143], a[16:19], v[224:227], v[128:143]
    ds_read_b128 v[244:247], v254 offset:9216
    v_fma_f32 v126, v126, v250, v250
    v_fma_f32 v127, v127, v250, v250
    v_rcp_f32 v124, v124
    v_mul_f32 v160, v160, v168
    v_mfma_f32_32x32x16_bf16 v[144:159], a[128:131], v[224:227], v[144:159]
    s_add_u32 m0, s87, 102400
    s_add_u32 s81, s76, 90112
    v_rcp_f32 v125, v125
    v_mul_f32 v161, v161, v169
    v_rcp_f32 v126, v126
    v_mfma_f32_32x32x16_bf16 v[128:143], a[20:23], v[228:231], v[128:143]
    ds_read_b128 v[224:227], v254 offset:10240
    buffer_load_dwordx4 v2, s[60:63], s81 offen offset:0 sc1 lds
    v_mul_f32 v162, v162, v170
    v_rcp_f32 v127, v127
    v_mul_f32 v163, v163, v171
    v_mfma_f32_32x32x16_bf16 v[144:159], a[132:135], v[228:231], v[144:159]
    s_waitcnt lgkmcnt(3)
    buffer_load_dwordx4 v2, s[60:63], s81 offen offset:1024 sc1 lds
    v_mul_f32 v160, v160, v124
    v_mul_f32 v161, v161, v125
    v_mul_f32 v162, v162, v126
    v_mul_f32_e64 v163, v163, v127
    s_add_u32 s22, s78, 114688
    v_mfma_f32_32x32x16_bf16 v[128:143], a[24:27], v[232:235], v[128:143]
    ds_read_b128 v[228:231], v254 offset:11264
    v_cvt_pk_bf16_f32 v116, v160, v161
    v_cvt_pk_bf16_f32 v117, v162, v163
    v_fmac_f32 v164, v248, v196
    v_fmac_f32 v165, v248, v197
    v_fmac_f32 v166, v248, v198
    v_mfma_f32_32x32x16_bf16 v[144:159], a[136:139], v[232:235], v[144:159]
    buffer_load_dwordx4 v2, s[60:63], s81 offen offset:2048 sc1 lds
    v_fmac_f32 v167, v248, v199
    v_mul_f32 v124, v249, v164
    v_mul_f32 v125, v249, v165
    v_mul_f32 v126, v249, v166
    v_mul_f32 v127, v249, v167
    v_mfma_f32_32x32x16_bf16 v[128:143], a[28:31], v[236:239], v[128:143]
    ds_read_b128 v[232:235], v254 offset:12288
    v_exp_f32 v124, v124
    v_fmac_f32 v172, v248, v204
    v_exp_f32 v125, v125
    v_mfma_f32_32x32x16_bf16 v[144:159], a[140:143], v[236:239], v[144:159]
    s_waitcnt lgkmcnt(3)
    s_add_u32 m0, s16, 4096
    s_add_u32 s81, s91, 71680
    v_fmac_f32 v173, v248, v205
    v_exp_f32 v126, v126
    v_mfma_f32_32x32x16_bf16 v[128:143], a[32:35], v[240:243], v[128:143]
    s_waitcnt vmcnt(12)
    ds_read_b128 v[236:239], v254 offset:13312
    buffer_store_dword v15, v14, s[60:63], s10 offen sc1
    v_fmac_f32 v174, v248, v206
    v_exp_f32 v127, v127
    v_fmac_f32 v175, v248, v207
    v_mfma_f32_32x32x16_bf16 v[144:159], a[144:147], v[240:243], v[144:159]
    buffer_load_dwordx4 v1, s[52:55], s81 offen offset:0  lds
    ds_read_b64_tr_b16 v[80:81], v10 offset:12288
    ds_read_b64_tr_b16 v[82:83], v10 offset:13312
    ds_read_b64_tr_b16 v[84:85], v11 offset:12288
    ds_read_b64_tr_b16 v[86:87], v11 offset:13312
    v_fma_f32 v124, v124, v250, v250
    v_mfma_f32_32x32x16_bf16 v[128:143], a[36:39], v[244:247], v[128:143]
    ds_read_b128 v[240:243], v254 offset:14336
    buffer_load_dwordx4 v4, s[52:55], s81 offen offset:1024  lds
    ds_read_b64_tr_b16 v[88:89], v113 offset:12288
    ds_read_b64_tr_b16 v[90:91], v113 offset:13312
    v_fma_f32 v125, v125, v250, v250
    v_fma_f32 v126, v126, v250, v250
    v_mfma_f32_32x32x16_bf16 v[144:159], a[148:151], v[244:247], v[144:159]
    s_waitcnt lgkmcnt(9)
    buffer_load_dwordx4 v5, s[52:55], s81 offen offset:2048  lds
    ds_read_b64_tr_b16 v[92:93], v114 offset:12288
    ds_read_b64_tr_b16 v[94:95], v114 offset:13312
    v_fma_f32 v127, v127, v250, v250
    v_rcp_f32 v124, v124
    v_mfma_f32_32x32x16_bf16 v[128:143], a[40:43], v[224:227], v[128:143]
    ds_read_b128 v[244:247], v254 offset:15360
    v_mul_f32 v164, v164, v172
    v_rcp_f32 v125, v125
    v_mul_f32 v165, v165, v173
    v_mfma_f32_32x32x16_bf16 v[144:159], a[152:155], v[224:227], v[144:159]
    v_rcp_f32 v126, v126
    v_mul_f32 v166, v166, v174
    v_rcp_f32 v127, v127
    v_mul_f32 v167, v167, v175
    v_mfma_f32_32x32x16_bf16 v[128:143], a[44:47], v[228:231], v[128:143]
    ds_read_b128 v[224:227], v254 offset:16384
    buffer_load_dwordx4 v6, s[52:55], s81 offen offset:3072  lds
    v_mul_f32 v164, v164, v124
    v_mul_f32 v165, v165, v125
    v_mul_f32 v166, v166, v126
    v_mul_f32 v167, v167, v127
    v_mfma_f32_32x32x16_bf16 v[144:159], a[156:159], v[228:231], v[144:159]
    s_waitcnt lgkmcnt(11) vmcnt(12)
Lc_48:
    v_cmp_ne_u32 vcc, s64, v12
    s_cbranch_vccnz Lr_49
Lk_50:
    v_cvt_pk_bf16_f32 v118, v164, v165
    v_cvt_pk_bf16_f32 v119, v166, v167
    v_mfma_f32_32x32x16_bf16 v[128:143], a[48:51], v[232:235], v[128:143]
    ds_read_b128 v[228:231], v254 offset:17408
    buffer_store_dwordx4 v[116:119], v2, s[60:63], s22 offen sc1
    s_add_u32 m0, s16, 8192
    s_add_u32 s81, s91, 129024
    v_fmac_f32 v176, v248, v208
    v_fmac_f32 v177, v248, v209
    v_mfma_f32_32x32x16_bf16 v[144:159], a[160:163], v[232:235], v[144:159]
    buffer_load_dwordx4 v1, s[52:55], s81 offen offset:0  lds
    v_fmac_f32 v178, v248, v210
    v_fmac_f32 v179, v248, v211
    v_mul_f32 v124, v249, v176
    v_mul_f32 v125, v249, v177
    v_mul_f32 v126, v249, v178
    v_mfma_f32_32x32x16_bf16 v[128:143], a[52:55], v[236:239], v[128:143]
    ds_read_b128 v[232:235], v254 offset:18432
    v_mul_f32 v127, v249, v179
    v_exp_f32 v124, v124
    v_fmac_f32 v184, v248, v216
    v_add_u32 v10, s92, v10
    v_mfma_f32_32x32x16_bf16 v[144:159], a[164:167], v[236:239], v[144:159]
    s_waitcnt lgkmcnt(3)
    buffer_load_dwordx4 v4, s[52:55], s81 offen offset:1024  lds
    v_exp_f32 v125, v125
    v_fmac_f32 v185, v248, v217
    v_exp_f32 v126, v126
    v_mfma_f32_32x32x16_bf16 v[128:143], a[56:59], v[240:243], v[128:143]
    ds_read_b128 v[236:239], v254 offset:19456
    v_fmac_f32 v186, v248, v218
    v_exp_f32 v127, v127
    v_fmac_f32 v187, v248, v219
    v_fma_f32 v124, v124, v250, v250
    v_mfma_f32_32x32x16_bf16 v[144:159], a[168:171], v[240:243], v[144:159]
    buffer_load_dwordx4 v5, s[52:55], s81 offen offset:2048  lds
    v_fma_f32 v125, v125, v250, v250
    v_fma_f32 v126, v126, v250, v250
    v_fma_f32 v127, v127, v250, v250
    v_rcp_f32 v124, v124
    v_mfma_f32_32x32x16_bf16 v[128:143], a[60:63], v[244:247], v[128:143]
    ds_read_b128 v[240:243], v254 offset:20480
    v_mul_f32 v176, v176, v184
    v_rcp_f32 v125, v125
    v_mul_f32 v177, v177, v185
    v_add_u32 v11, s92, v11
    v_mfma_f32_32x32x16_bf16 v[144:159], a[172:175], v[244:247], v[144:159]
    s_waitcnt lgkmcnt(3)
    buffer_load_dwordx4 v6, s[52:55], s81 offen offset:3072  lds
    v_rcp_f32 v126, v126
    v_mul_f32 v178, v178, v186
    v_rcp_f32 v127, v127
    v_mfma_f32_32x32x16_bf16 v[128:143], a[64:67], v[224:227], v[128:143]
    ds_read_b128 v[244:247], v254 offset:21504
    v_mul_f32 v179, v179, v187
    v_mul_f32 v176, v176, v124
    v_mul_f32 v177, v177, v125
    v_mul_f32 v178, v178, v126
    v_mul_f32 v179, v179, v127
    v_mfma_f32_32x32x16_bf16 v[144:159], a[176:179], v[224:227], v[144:159]
    s_add_u32 s6, s78, 172032
    v_cvt_pk_bf16_f32 v120, v176, v177
    v_cvt_pk_bf16_f32 v121, v178, v179
    v_fmac_f32 v180, v248, v212
    v_fmac_f32 v181, v248, v213
    v_fmac_f32 v182, v248, v214
    v_fmac_f32 v183, v248, v215
    v_mfma_f32_32x32x16_bf16 v[128:143], a[68:71], v[228:231], v[128:143]
    ds_read_b128 v[224:227], v254 offset:22528
    s_add_u32 m0, s16, 12288
    s_add_u32 s81, s91, 186368
    v_mul_f32 v124, v249, v180
    v_mul_f32 v125, v249, v181
    v_mul_f32 v126, v249, v182
    v_mfma_f32_32x32x16_bf16 v[144:159], a[180:183], v[228:231], v[144:159]
    s_waitcnt lgkmcnt(3)
    buffer_load_dwordx4 v1, s[52:55], s81 offen offset:0  lds
    v_mul_f32 v127, v249, v183
    v_exp_f32 v124, v124
    v_fmac_f32 v188, v248, v220
    v_add_u32 v113, s92, v113
    v_mfma_f32_32x32x16_bf16 v[128:143], a[72:75], v[232:235], v[128:143]
    ds_read_b128 v[228:231], v254 offset:23552
    buffer_load_dwordx4 v4, s[52:55], s81 offen offset:1024  lds
    v_exp_f32 v125, v125
    v_fmac_f32 v189, v248, v221
    v_add_u32_e64 v114, s92, v114
    v_mfma_f32_32x32x16_bf16 v[144:159], a[184:187], v[232:235], v[144:159]
    ds_read_b64_tr_b16 v[96:97], v10 offset:4096
    ds_read_b64_tr_b16 v[98:99], v10 offset:5120
    ds_read_b64_tr_b16 v[100:101], v11 offset:4096
    ds_read_b64_tr_b16 v[102:103], v11 offset:5120
    v_exp_f32_e64 v126, v126
    v_mfma_f32_32x32x16_bf16 v[128:143], a[76:79], v[236:239], v[128:143]
    ds_read_b128 v[232:235], v254 offset:24576
    ds_read_b64_tr_b16 v[104:105], v113 offset:4096
    ds_read_b64_tr_b16 v[106:107], v113 offset:5120
    v_fmac_f32 v190, v248, v222
    v_exp_f32 v127, v127
    v_mfma_f32_32x32x16_bf16 v[144:159], a[188:191], v[236:239], v[144:159]
    s_waitcnt lgkmcnt(9)
    buffer_load_dwordx4 v5, s[52:55], s81 offen offset:2048  lds
    ds_read_b64_tr_b16 v[108:109], v114 offset:4096
    ds_read_b64_tr_b16 v[110:111], v114 offset:5120
    v_fmac_f32 v191, v248, v223
    v_fma_f32 v124, v124, v250, v250
    v_fma_f32 v125, v125, v250, v250
    v_mfma_f32_32x32x16_bf16 v[128:143], a[80:83], v[240:243], v[128:143]
    ds_read_b128 v[236:239], v254 offset:25600
    ds_read_b64_tr_b16 a[224:225], v10 offset:0
    ds_read_b64_tr_b16 a[226:227], v10 offset:1024
    v_fma_f32 v126, v126, v250, v250
    v_fma_f32 v127, v127, v250, v250
    v_mfma_f32_32x32x16_bf16 v[144:159], a[192:195], v[240:243], v[144:159]
    buffer_load_dwordx4 v6, s[52:55], s81 offen offset:3072  lds
    ds_read_b64_tr_b16 a[228:229], v11 offset:0
    ds_read_b64_tr_b16 a[230:231], v11 offset:1024
    ds_read_b64_tr_b16 a[232:233], v113 offset:0
    ds_read_b64_tr_b16 a[234:235], v113 offset:1024
    v_mfma_f32_32x32x16_bf16 v[128:143], a[84:87], v[244:247], v[128:143]
    ds_read_b128 v[240:243], v254 offset:26624
    ds_read_b64_tr_b16 a[236:237], v114 offset:0
    ds_read_b64_tr_b16 a[238:239], v114 offset:1024
    v_rcp_f32 v124, v124
    v_mul_f32 v180, v180, v188
    v_mfma_f32_32x32x16_bf16 v[144:159], a[196:199], v[244:247], v[144:159]
    s_waitcnt lgkmcnt(15)
    s_waitcnt lgkmcnt(10)
    s_add_u32 m0, s90, 4096
    s_add_u32 s81, s91, 243712
    v_rcp_f32 v125, v125
    v_mul_f32 v181, v181, v189
    v_mfma_f32_32x32x16_bf16 v[128:143], a[88:91], v[224:227], v[128:143]
    ds_read_b128 v[244:247], v254 offset:27648
    buffer_load_dwordx4 v1, s[52:55], s81 offen offset:0  lds
    v_rcp_f32 v126, v126
    v_mul_f32 v182, v182, v190
    v_subrev_u32 v10, s92, v10
    v_mfma_f32_32x32x16_bf16 v[144:159], a[200:203], v[224:227], v[144:159]
    s_waitcnt vmcnt(15)
    s_barrier
    v_rcp_f32 v127, v127
    v_mul_f32 v183, v183, v191
    v_mul_f32 v180, v180, v124
    v_mfma_f32_32x32x16_bf16 v[128:143], a[92:95], v[228:231], v[128:143]
    ds_read_b128 v[224:227], v254 offset:32768
    buffer_load_dwordx4 v4, s[52:55], s81 offen offset:1024  lds
    v_lshlrev_b32 v112, 6, v0
    v_mov_b32 v253, v15
    v_mul_f32 v181, v181, v125
    v_mul_f32 v182, v182, v126
    v_mfma_f32_32x32x16_bf16 v[144:159], a[204:207], v[228:231], v[144:159]
    s_waitcnt lgkmcnt(11)
La_41:
    s_mov_b64 exec, 16383
    buffer_load_dword v253, v112, s[60:63], s20 offen sc1
    s_mov_b64 exec, -1
Lb_42:
    v_mul_f32_e64 v183, v183, v127
    v_cvt_pk_bf16_f32 v122, v180, v181
    v_cvt_pk_bf16_f32 v123, v182, v183
    v_mfma_f32_32x32x16_bf16 v[128:143], a[96:99], v[232:235], v[128:143]
    ds_read_b128 v[228:231], v254 offset:33792
    buffer_load_dwordx4 v5, s[52:55], s81 offen offset:2048  lds
    v_subrev_u32 v11, s92, v11
    v_subrev_u32 v113, s92, v113
    v_subrev_u32 v114, s92, v114
    v_mfma_f32_32x32x16_bf16 v[144:159], a[208:211], v[232:235], v[144:159]
    buffer_store_dwordx4 v[120:123], v2, s[60:63], s6 offen sc1
    ds_read_b64_tr_b16 a[240:241], v10 offset:0
    ds_read_b64_tr_b16 a[242:243], v10 offset:1024
    ds_read_b64_tr_b16 a[244:245], v11 offset:0
    ds_read_b64_tr_b16 a[246:247], v11 offset:1024
L_pb2:
    s_cbranch_execz L_wr_r
    v_mfma_f32_32x32x16_bf16 v[128:143], a[100:103], v[236:239], v[128:143]
    ds_read_b128 v[232:235], v254 offset:34816
    ds_read_b64_tr_b16 a[248:249], v113 offset:0
    ds_read_b64_tr_b16 a[250:251], v113 offset:1024
    v_mfma_f32_32x32x16_bf16 v[144:159], a[212:215], v[236:239], v[144:159]
    s_waitcnt lgkmcnt(9)
    buffer_load_dwordx4 v6, s[52:55], s81 offen offset:3072  lds
    ds_read_b64_tr_b16 a[252:253], v114 offset:0
    ds_read_b64_tr_b16 a[254:255], v114 offset:1024
    v_mfma_f32_32x32x16_bf16 v[128:143], a[104:107], v[240:243], v[128:143]
    ds_read_b128 v[236:239], v254 offset:35840
    v_mfma_f32_32x32x16_bf16 v[144:159], a[216:219], v[240:243], v[144:159]
    s_add_u32 m0, s90, 0
    s_add_u32 s81, s91, 301056
    v_mfma_f32_32x32x16_bf16 v[128:143], a[108:111], v[244:247], v[128:143]
    ds_read_b128 v[240:243], v254 offset:36864
    buffer_load_dwordx4 v1, s[52:55], s81 offen offset:0  lds
    v_mfma_f32_32x32x16_bf16 v[144:159], a[220:223], v[244:247], v[144:159]
    s_waitcnt lgkmcnt(11)
    buffer_load_dwordx4 v4, s[52:55], s81 offen offset:1024  lds
    v_mfma_f32_32x32x16_bf16 v[160:175], a[0:3], v[224:227], 0
    ds_read_b128 v[244:247], v254 offset:37888
    ds_read_b128 v[248:251], v9 offset:1024
    v_mfma_f32_32x32x16_bf16 v[176:191], a[112:115], v[224:227], 0
    v_mfma_f32_32x32x16_bf16 v[160:175], a[4:7], v[228:231], v[160:175]
    ds_read_b128 v[224:227], v254 offset:38912
    buffer_load_dwordx4 v5, s[52:55], s81 offen offset:2048  lds
    v_mfma_f32_32x32x16_bf16 v[176:191], a[116:119], v[228:231], v[176:191]
    s_waitcnt lgkmcnt(4)
    s_waitcnt lgkmcnt(1)
    v_fmac_f32 v128, v248, v192
    v_fmac_f32 v129, v248, v193
    v_fmac_f32 v130, v248, v194
    v_fmac_f32 v131, v248, v195
    v_mul_f32 v124, v249, v128
    v_mfma_f32_32x32x16_bf16 v[160:175], a[8:11], v[232:235], v[160:175]
    ds_read_b128 v[228:231], v254 offset:39936
    buffer_load_dwordx4 v6, s[52:55], s81 offen offset:3072  lds
    v_mul_f32 v125, v249, v129
    v_mul_f32 v126, v249, v130
    v_mul_f32 v127, v249, v131
    v_mfma_f32_32x32x16_bf16 v[176:191], a[120:123], v[232:235], v[176:191]
    v_exp_f32 v124, v124
    v_fmac_f32 v136, v248, v200
    v_exp_f32 v125, v125
    v_fmac_f32 v137, v248, v201
    v_mfma_f32_32x32x16_bf16 v[160:175], a[12:15], v[236:239], v[160:175]
    ds_read_b128 v[232:235], v254 offset:40960
    v_exp_f32 v126, v126
    v_fmac_f32 v138, v248, v202
    v_exp_f32 v127, v127
    v_mfma_f32_32x32x16_bf16 v[176:191], a[124:127], v[236:239], v[176:191]
    s_add_u32 m0, s16, 0
    s_add_u32 s81, s91, 358400
    v_fmac_f32_e64 v139, v248, v203
    v_fma_f32 v124, v124, v250, v250
    v_fma_f32 v125, v125, v250, v250
    v_mfma_f32_32x32x16_bf16 v[160:175], a[16:19], v[240:243], v[160:175]
    s_waitcnt vmcnt(19)
    ds_read_b128 v[236:239], v254 offset:41984
    buffer_load_dwordx4 v1, s[52:55], s81 offen offset:0  lds
    ds_read_b64_tr_b16 a[112:113], v10 offset:4096
    ds_read_b64_tr_b16 a[114:115], v10 offset:5120
    v_fma_f32 v126, v126, v250, v250
    v_fma_f32 v127, v127, v250, v250
    v_mfma_f32_32x32x16_bf16 v[176:191], a[128:131], v[240:243], v[176:191]
    buffer_load_dwordx4 v4, s[52:55], s81 offen offset:1024  lds
    ds_read_b64_tr_b16 a[116:117], v11 offset:4096
    ds_read_b64_tr_b16 a[118:119], v11 offset:5120
    ds_read_b64_tr_b16 a[120:121], v113 offset:4096
    ds_read_b64_tr_b16 a[122:123], v113 offset:5120
    v_mfma_f32_32x32x16_bf16 v[160:175], a[20:23], v[244:247], v[160:175]
    ds_read_b128 v[240:243], v254 offset:43008
    ds_read_b64_tr_b16 a[124:125], v114 offset:4096
    ds_read_b64_tr_b16 a[126:127], v114 offset:5120
    v_rcp_f32 v124, v124
    v_mul_f32 v128, v128, v136
    v_mfma_f32_32x32x16_bf16 v[176:191], a[132:135], v[244:247], v[176:191]
    s_waitcnt lgkmcnt(11)
    buffer_load_dwordx4 v5, s[52:55], s81 offen offset:2048  lds
    v_rcp_f32 v125, v125
    v_mul_f32 v129, v129, v137
    v_rcp_f32 v126, v126
    v_mfma_f32_32x32x16_bf16 v[160:175], a[24:27], v[224:227], v[160:175]
    ds_read_b128 v[244:247], v254 offset:44032
    v_mul_f32 v130, v130, v138
    v_rcp_f32 v127, v127
    v_mul_f32 v131, v131, v139
    v_mul_f32 v128, v128, v124
    v_mfma_f32_32x32x16_bf16 v[176:191], a[136:139], v[224:227], v[176:191]
    v_mul_f32 v129, v129, v125
    v_mul_f32 v130, v130, v126
    v_mul_f32_e64 v131, v131, v127
    s_add_u32 s22, s78, 229376
    v_cvt_pk_bf16_f32 v116, v128, v129
    v_cvt_pk_bf16_f32 v117, v130, v131
    v_mfma_f32_32x32x16_bf16 v[160:175], a[28:31], v[228:231], v[160:175]
    ds_read_b128 v[224:227], v254 offset:45056
    buffer_load_dwordx4 v6, s[52:55], s81 offen offset:3072  lds
    v_fmac_f32 v132, v248, v196
    v_fmac_f32 v133, v248, v197
    v_fmac_f32 v134, v248, v198
    v_fmac_f32 v135, v248, v199
    v_mfma_f32_32x32x16_bf16 v[176:191], a[140:143], v[228:231], v[176:191]
    s_waitcnt lgkmcnt(11) vmcnt(11)
Lc_43:
    v_cmp_ne_u32 vcc, s64, v253
    s_cbranch_vccnz Lr_44
Lk_45:
    v_mul_f32 v124, v249, v132
    v_mul_f32 v125, v249, v133
    v_mul_f32 v126, v249, v134
    v_mfma_f32_32x32x16_bf16 v[160:175], a[32:35], v[232:235], v[160:175]
    ds_read_b128 v[228:231], v254 offset:46080
    ds_read_b64_tr_b16 a[128:129], v10 offset:8192
    ds_read_b64_tr_b16 a[130:131], v10 offset:9216
    s_add_u32 s80, s79, 0
    v_mul_f32 v127, v249, v135
    v_mfma_f32_32x32x16_bf16 v[176:191], a[144:147], v[232:235], v[176:191]
    buffer_load_dwordx4 a[0:3], v3, s[60:63], s80 offen offset:0 sc1
    ds_read_b64_tr_b16 a[132:133], v11 offset:8192
    ds_read_b64_tr_b16 a[134:135], v11 offset:9216
    ds_read_b64_tr_b16 a[136:137], v113 offset:8192
    ds_read_b64_tr_b16 a[138:139], v113 offset:9216
    v_mfma_f32_32x32x16_bf16 v[160:175], a[36:39], v[236:239], v[160:175]
    ds_read_b128 v[232:235], v254 offset:47104
    buffer_load_dwordx4 a[4:7], v3, s[60:63], s80 offen offset:256 sc1
    ds_read_b64_tr_b16 a[140:141], v114 offset:8192
    ds_read_b64_tr_b16 a[142:143], v114 offset:9216
    v_exp_f32 v124, v124
    v_mfma_f32_32x32x16_bf16 v[176:191], a[148:151], v[236:239], v[176:191]
    s_waitcnt lgkmcnt(11)
    v_fmac_f32 v140, v248, v204
    v_exp_f32 v125, v125
    v_fmac_f32 v141, v248, v205
    v_exp_f32 v126, v126
    v_mfma_f32_32x32x16_bf16 v[160:175], a[40:43], v[240:243], v[160:175]
    ds_read_b128 v[236:239], v254 offset:48128
    buffer_load_dwordx4 a[8:11], v3, s[60:63], s80 offen offset:2048 sc1
    v_fmac_f32 v142, v248, v206
    v_exp_f32 v127, v127
    v_fmac_f32_e64 v143, v248, v207
    v_mfma_f32_32x32x16_bf16 v[176:191], a[152:155], v[240:243], v[176:191]
    v_fma_f32 v124, v124, v250, v250
    v_fma_f32 v125, v125, v250, v250
    v_fma_f32 v126, v126, v250, v250
    v_fma_f32 v127, v127, v250, v250
    v_rcp_f32 v124, v124
    v_mfma_f32_32x32x16_bf16 v[160:175], a[44:47], v[244:247], v[160:175]
    ds_read_b128 v[240:243], v254 offset:49152
    buffer_load_dwordx4 a[12:15], v3, s[60:63], s80 offen offset:2304 sc1
    v_mul_f32 v132, v132, v140
    v_rcp_f32 v125, v125
    v_mul_f32 v133, v133, v141
    v_mfma_f32_32x32x16_bf16 v[176:191], a[156:159], v[244:247], v[176:191]
    s_waitcnt lgkmcnt(11)
    v_rcp_f32 v126, v126
    v_mul_f32 v134, v134, v142
    v_rcp_f32 v127, v127
    v_mul_f32_e64 v135, v135, v143
    v_mfma_f32_32x32x16_bf16 v[160:175], a[48:51], v[224:227], v[160:175]
    ds_read_b128 v[244:247], v254 offset:50176
    ds_read_b64_tr_b16 a[144:145], v10 offset:12288
    ds_read_b64_tr_b16 a[146:147], v10 offset:13312
    s_add_u32 s80, s79, 4096
    v_mul_f32 v132, v132, v124
    v_mul_f32 v133, v133, v125
    v_mfma_f32_32x32x16_bf16 v[176:191], a[160:163], v[224:227], v[176:191]
    buffer_load_dwordx4 a[16:19], v3, s[60:63], s80 offen offset:0 sc1
    ds_read_b64_tr_b16 a[148:149], v11 offset:12288
    ds_read_b64_tr_b16 a[150:151], v11 offset:13312
    ds_read_b64_tr_b16 a[152:153], v113 offset:12288
    ds_read_b64_tr_b16 a[154:155], v113 offset:13312
    v_mul_f32_e64 v134, v134, v126
    v_mfma_f32_32x32x16_bf16 v[160:175], a[52:55], v[228:231], v[160:175]
    ds_read_b128 v[224:227], v254 offset:51200
    ds_read_b64_tr_b16 a[156:157], v114 offset:12288
    ds_read_b64_tr_b16 a[158:159], v114 offset:13312
    v_mul_f32 v135, v135, v127
    v_cvt_pk_bf16_f32 v118, v132, v133
    v_cvt_pk_bf16_f32 v119, v134, v135
    v_mfma_f32_32x32x16_bf16 v[176:191], a[164:167], v[228:231], v[176:191]
    s_waitcnt lgkmcnt(11)
    buffer_load_dwordx4 a[20:23], v3, s[60:63], s80 offen offset:256 sc1
    v_mfma_f32_32x32x16_bf16 v[160:175], a[56:59], v[232:235], v[160:175]
    ds_read_b128 v[228:231], v254 offset:52224
    buffer_store_dwordx4 v[116:119], v2, s[60:63], s22 offen sc1
    v_fmac_f32 v144, v248, v208
    v_fmac_f32 v145, v248, v209
    v_fmac_f32 v146, v248, v210
    v_fmac_f32 v147, v248, v211
    v_mfma_f32_32x32x16_bf16 v[176:191], a[168:171], v[232:235], v[176:191]
    buffer_load_dwordx4 a[24:27], v3, s[60:63], s80 offen offset:2048 sc1
    v_mul_f32 v124, v249, v144
    v_mul_f32 v125, v249, v145
    v_mul_f32 v126, v249, v146
    v_mul_f32 v127, v249, v147
    v_mfma_f32_32x32x16_bf16 v[160:175], a[60:63], v[236:239], v[160:175]
    ds_read_b128 v[232:235], v254 offset:53248
    v_exp_f32 v124, v124
    v_fmac_f32 v152, v248, v216
    v_exp_f32 v125, v125
    v_mfma_f32_32x32x16_bf16 v[176:191], a[172:175], v[236:239], v[176:191]
    s_waitcnt lgkmcnt(11)
    buffer_load_dwordx4 a[28:31], v3, s[60:63], s80 offen offset:2304 sc1
    v_fmac_f32 v153, v248, v217
    v_exp_f32 v126, v126
    v_fmac_f32 v154, v248, v218
    v_mfma_f32_32x32x16_bf16 v[160:175], a[64:67], v[240:243], v[160:175]
    ds_read_b128 v[236:239], v254 offset:54272
    v_exp_f32 v127, v127
    v_fmac_f32_e64 v155, v248, v219
    v_fma_f32 v124, v124, v250, v250
    v_fma_f32 v125, v125, v250, v250
    v_mfma_f32_32x32x16_bf16 v[176:191], a[176:179], v[240:243], v[176:191]
    s_add_u32 s80, s79, 8192
    v_fma_f32 v126, v126, v250, v250
    v_fma_f32 v127, v127, v250, v250
    v_rcp_f32 v124, v124
    v_mul_f32 v144, v144, v152
    v_add_u32 v10, s92, v10
    v_mfma_f32_32x32x16_bf16 v[160:175], a[68:71], v[244:247], v[160:175]
    ds_read_b128 v[240:243], v254 offset:55296
    buffer_load_dwordx4 a[32:35], v3, s[60:63], s80 offen offset:0 sc1
    v_rcp_f32 v125, v125
    v_mul_f32 v145, v145, v153
    v_add_u32 v11, s92, v11
    v_mfma_f32_32x32x16_bf16 v[176:191], a[180:183], v[244:247], v[176:191]
    s_waitcnt lgkmcnt(3)
    v_rcp_f32 v126, v126
    v_mul_f32 v146, v146, v154
    v_rcp_f32 v127, v127
    v_mul_f32 v147, v147, v155
    v_mfma_f32_32x32x16_bf16 v[160:175], a[72:75], v[224:227], v[160:175]
    ds_read_b128 v[244:247], v254 offset:56320
    buffer_load_dwordx4 a[36:39], v3, s[60:63], s80 offen offset:256 sc1
    v_mul_f32 v144, v144, v124
    v_mul_f32 v145, v145, v125
    v_mul_f32 v146, v146, v126
    v_mul_f32_e64 v147, v147, v127
    v_mfma_f32_32x32x16_bf16 v[176:191], a[184:187], v[224:227], v[176:191]
    s_add_u32 s6, s78, 286720
    v_cvt_pk_bf16_f32 v120, v144, v145
    v_cvt_pk_bf16_f32 v121, v146, v147
    v_fmac_f32 v148, v248, v212
    v_fmac_f32 v149, v248, v213
    v_fmac_f32 v150, v248, v214
    v_fmac_f32 v151, v248, v215
    v_mfma_f32_32x32x16_bf16 v[160:175], a[76:79], v[228:231], v[160:175]
    ds_read_b128 v[224:227], v254 offset:57344
    buffer_load_dwordx4 a[40:43], v3, s[60:63], s80 offen offset:2048 sc1
    v_mul_f32 v124, v249, v148
    v_mul_f32 v125, v249, v149
    v_mul_f32 v126, v249, v150
    v_mul_f32 v127, v249, v151
    v_mfma_f32_32x32x16_bf16 v[176:191], a[188:191], v[228:231], v[176:191]
    s_waitcnt lgkmcnt(3)
    v_exp_f32 v124, v124
    v_fmac_f32 v156, v248, v220
    v_exp_f32 v125, v125
    v_fmac_f32 v157, v248, v221
    v_mfma_f32_32x32x16_bf16 v[160:175], a[80:83], v[232:235], v[160:175]
    ds_read_b128 v[228:231], v254 offset:58368
    buffer_load_dwordx4 a[44:47], v3, s[60:63], s80 offen offset:2304 sc1
    v_exp_f32 v126, v126
    v_fmac_f32 v158, v248, v222
    v_add_u32 v113, s92, v113
    v_mfma_f32_32x32x16_bf16 v[176:191], a[192:195], v[232:235], v[176:191]
    v_exp_f32 v127, v127
    v_fmac_f32 v159, v248, v223
    v_fma_f32 v124, v124, v250, v250
    v_fma_f32 v125, v125, v250, v250
    v_fma_f32 v126, v126, v250, v250
    v_mfma_f32_32x32x16_bf16 v[160:175], a[84:87], v[236:239], v[160:175]
    ds_read_b128 v[232:235], v254 offset:59392
    s_add_u32 s80, s79, 12288
    v_fma_f32 v127, v127, v250, v250
    v_rcp_f32 v124, v124
    v_mul_f32 v148, v148, v156
    v_mfma_f32_32x32x16_bf16 v[176:191], a[196:199], v[236:239], v[176:191]
    s_waitcnt lgkmcnt(3)
    buffer_load_dwordx4 a[48:51], v3, s[60:63], s80 offen offset:0 sc1
    v_rcp_f32 v125, v125
    v_mul_f32 v149, v149, v157
    v_rcp_f32 v126, v126
    v_mfma_f32_32x32x16_bf16 v[160:175], a[88:91], v[240:243], v[160:175]
    ds_read_b128 v[236:239], v254 offset:60416
    buffer_load_dwordx4 a[52:55], v3, s[60:63], s80 offen offset:256 sc1
    v_mul_f32 v150, v150, v158
    v_rcp_f32 v127, v127
    v_mul_f32 v151, v151, v159
    v_mfma_f32_32x32x16_bf16 v[176:191], a[200:203], v[240:243], v[176:191]
    v_mul_f32 v148, v148, v124
    v_mul_f32 v149, v149, v125
    v_mul_f32 v150, v150, v126
    v_mul_f32_e64 v151, v151, v127
    v_cvt_pk_bf16_f32 v122, v148, v149
    v_cvt_pk_bf16_f32 v123, v150, v151
    v_mfma_f32_32x32x16_bf16 v[160:175], a[92:95], v[244:247], v[160:175]
    buffer_store_dwordx4 v[120:123], v2, s[60:63], s6 offen sc1
    ds_read_b128 v[248:251], v9 offset:1536
    v_add_u32_e64 v114, s92, v114
    s_waitcnt vmcnt(24)
    v_mfma_f32_32x32x16_bf16 v[176:191], a[204:207], v[244:247], v[176:191]
    s_waitcnt lgkmcnt(3)
    ds_read_b64_tr_b16 a[160:161], v10 offset:4096
    ds_read_b64_tr_b16 a[162:163], v10 offset:5120
    ds_read_b64_tr_b16 a[164:165], v11 offset:4096
    ds_read_b64_tr_b16 a[166:167], v11 offset:5120
    s_add_u32 s80, s79, 57344
    v_mfma_f32_32x32x16_bf16 v[160:175], a[96:99], v[224:227], v[160:175]
    buffer_load_dwordx4 a[56:59], v3, s[60:63], s80 offen offset:0 sc1
    ds_read_b64_tr_b16 a[168:169], v113 offset:4096
    ds_read_b64_tr_b16 a[170:171], v113 offset:5120
    ds_read_b64_tr_b16 a[172:173], v114 offset:4096
    ds_read_b64_tr_b16 a[174:175], v114 offset:5120
    s_waitcnt vmcnt(21)
    v_mfma_f32_32x32x16_bf16 v[176:191], a[208:211], v[224:227], v[176:191]
    buffer_load_dwordx4 a[60:63], v3, s[60:63], s80 offen offset:256 sc1
    ds_read_b64_tr_b16 a[176:177], v10 offset:0
    ds_read_b64_tr_b16 a[178:179], v10 offset:1024
    ds_read_b64_tr_b16 a[180:181], v11 offset:0
    ds_read_b64_tr_b16 a[182:183], v11 offset:1024
    v_mfma_f32_32x32x16_bf16 v[160:175], a[100:103], v[228:231], v[160:175]
    ds_read_b64_tr_b16 a[184:185], v113 offset:0
    ds_read_b64_tr_b16 a[186:187], v113 offset:1024
    ds_read_b64_tr_b16 a[188:189], v114 offset:0
    ds_read_b64_tr_b16 a[190:191], v114 offset:1024
    v_subrev_u32 v10, s92, v10
    v_subrev_u32 v11, s92, v11
    v_mfma_f32_32x32x16_bf16 v[176:191], a[212:215], v[228:231], v[176:191]
    s_waitcnt lgkmcnt(15)
    buffer_load_dwordx4 a[64:67], v3, s[60:63], s80 offen offset:2048 sc1
    s_waitcnt vmcnt(15)
    v_accvgpr_read_b32 v116, a0
    v_accvgpr_read_b32 v117, a4
    v_accvgpr_read_b32 v118, a8
    v_accvgpr_read_b32 v119, a12
    v_mfma_f32_32x32x16_bf16 v[160:175], a[104:107], v[232:235], v[160:175]
    v_max3_u32 v252, v116, v117, v118
    v_max_u32_e64 v252, v252, v119
    v_cmp_eq_u32 vcc, -1, v252
    v_subrev_u32 v113, s92, v113
    v_subrev_u32 v114, s92, v114
    v_mfma_f32_32x32x16_bf16 v[176:191], a[216:219], v[232:235], v[176:191]
    buffer_load_dwordx4 a[68:71], v3, s[60:63], s80 offen offset:2304 sc1
    ds_read_b64_tr_b16 a[192:193], v10 offset:0
    ds_read_b64_tr_b16 a[194:195], v10 offset:1024
    ds_read_b64_tr_b16 a[196:197], v11 offset:0
    ds_read_b64_tr_b16 a[198:199], v11 offset:1024
    v_mfma_f32_32x32x16_bf16 v[160:175], a[108:111], v[236:239], v[160:175]
    ds_read_b64_tr_b16 a[200:201], v113 offset:0
    ds_read_b64_tr_b16 a[202:203], v113 offset:1024
    ds_read_b64_tr_b16 a[204:205], v114 offset:0
    ds_read_b64_tr_b16 a[206:207], v114 offset:1024
Lc_51:
    s_cbranch_vccnz Lr_52
Lk_53:
    v_mfma_f32_32x32x16_bf16 v[176:191], a[220:223], v[236:239], v[176:191]
    s_waitcnt lgkmcnt(15)
    s_add_u32 s80, s79, 61440
    buffer_load_dwordx4 a[72:75], v3, s[60:63], s80 offen offset:0 sc1
    buffer_load_dwordx4 a[76:79], v3, s[60:63], s80 offen offset:256 sc1
    s_mul_i32 s20, s65, 28672
    s_lshl_b32 s76, s27, 2
    s_add_u32 s76, s76, s3
    s_lshl_b32 s77, s76, 10
    s_add_u32 s77, s77, s20
    s_add_u32 s77, s77, 8388608
    s_lshl_b32 s76, s76, 5
    s_add_u32 s76, s76, s20
    v_pk_fma_f32 v[160:161], v[192:193], v[248:249], v[160:161] op_sel_hi:[1,0,1]
    v_pk_fma_f32 v[162:163], v[194:195], v[248:249], v[162:163] op_sel_hi:[1,0,1]
    v_pk_mul_f32 v[124:125], v[160:161], v[248:249] op_sel:[0,1] op_sel_hi:[1,1]
    v_pk_mul_f32 v[126:127], v[162:163], v[248:249] op_sel:[0,1] op_sel_hi:[1,1]
    v_exp_f32 v124, v124
    v_exp_f32 v125, v125
    v_exp_f32 v126, v126
    v_exp_f32 v127, v127
    v_pk_fma_f32 v[168:169], v[200:201], v[248:249], v[168:169] op_sel_hi:[1,0,1]
    v_pk_fma_f32 v[170:171], v[202:203], v[248:249], v[170:171] op_sel_hi:[1,0,1]
    v_pk_fma_f32 v[124:125], v[124:125], v[250:251], v[250:251] op_sel_hi:[1,0,0]
    v_pk_fma_f32 v[126:127], v[126:127], v[250:251], v[250:251] op_sel_hi:[1,0,0]
    v_rcp_f32 v124, v124
    v_rcp_f32 v125, v125
    v_rcp_f32 v126, v126
    v_rcp_f32 v127, v127
    v_pk_mul_f32 v[160:161], v[160:161], v[168:169]
    v_pk_mul_f32 v[162:163], v[162:163], v[170:171]
    v_pk_mul_f32 v[160:161], v[160:161], v[124:125]
    v_pk_mul_f32 v[162:163], v[162:163], v[126:127]
    s_add_u32 s22, s78, 344064
    v_cvt_pk_bf16_f32 v116, v160, v161
    v_cvt_pk_bf16_f32 v117, v162, v163
    v_pk_fma_f32 v[164:165], v[196:197], v[248:249], v[164:165] op_sel_hi:[1,0,1]
    v_pk_fma_f32 v[166:167], v[198:199], v[248:249], v[166:167] op_sel_hi:[1,0,1]
    v_pk_mul_f32 v[124:125], v[164:165], v[248:249] op_sel:[0,1] op_sel_hi:[1,1]
    v_pk_mul_f32 v[126:127], v[166:167], v[248:249] op_sel:[0,1] op_sel_hi:[1,1]
    v_exp_f32 v124, v124
    v_exp_f32 v125, v125
    v_exp_f32 v126, v126
    v_exp_f32 v127, v127
    v_pk_fma_f32 v[172:173], v[204:205], v[248:249], v[172:173] op_sel_hi:[1,0,1]
    v_pk_fma_f32 v[174:175], v[206:207], v[248:249], v[174:175] op_sel_hi:[1,0,1]
    v_pk_fma_f32 v[124:125], v[124:125], v[250:251], v[250:251] op_sel_hi:[1,0,0]
    v_pk_fma_f32 v[126:127], v[126:127], v[250:251], v[250:251] op_sel_hi:[1,0,0]
    v_rcp_f32 v124, v124
    v_rcp_f32 v125, v125
    v_rcp_f32 v126, v126
    v_rcp_f32 v127, v127
    v_pk_mul_f32 v[164:165], v[164:165], v[172:173]
    v_pk_mul_f32 v[166:167], v[166:167], v[174:175]
    v_pk_mul_f32 v[164:165], v[164:165], v[124:125]
    v_pk_mul_f32 v[166:167], v[166:167], v[126:127]
    v_cvt_pk_bf16_f32 v118, v164, v165
    v_cvt_pk_bf16_f32 v119, v166, v167
    buffer_store_dwordx4 v[116:119], v2, s[60:63], s22 offen sc1
    s_waitcnt lgkmcnt(0)
    v_mfma_f32_16x16x32_bf16 v[136:139], v[20:23], a[0:3], 0
    buffer_load_dwordx4 a[80:83], v3, s[60:63], s80 offen offset:2048 sc1
    v_fmac_f32 v176, v248, v208
    v_fmac_f32 v177, v248, v209
    v_fmac_f32 v178, v248, v210
    v_mfma_f32_16x16x32_bf16 v[136:139], v[36:39], a[8:11], v[136:139]
    s_xor_b32 s20, s3, 1
    v_fmac_f32 v179, v248, v211
    v_mul_f32 v124, v249, v176
    v_mul_f32 v125, v249, v177
    v_mul_f32 v126, v249, v178
    v_mfma_f32_16x16x32_bf16 v[140:143], v[20:23], a[4:7], 0
    buffer_load_dwordx4 a[84:87], v3, s[60:63], s80 offen offset:2304 sc1
    v_mul_f32 v127, v249, v179
    v_exp_f32 v124, v124
    v_mfma_f32_16x16x32_bf16 v[140:143], v[36:39], a[12:15], v[140:143]
    s_mul_i32 s20, s20, 6144
    v_exp_f32 v125, v125
    v_exp_f32 v126, v126
    v_mfma_f32_16x16x32_bf16 v[144:147], v[24:27], a[0:3], 0
    v_exp_f32 v127, v127
    v_fmac_f32 v184, v248, v216
    v_fmac_f32 v185, v248, v217
    v_mfma_f32_16x16x32_bf16 v[144:147], v[40:43], a[8:11], v[144:147]
    s_add_u32 s80, s79, 65536
    buffer_load_dwordx4 a[88:91], v3, s[60:63], s80 offen offset:0 sc1
    v_fmac_f32 v186, v248, v218
    v_fmac_f32 v187, v248, v219
    v_mfma_f32_16x16x32_bf16 v[148:151], v[24:27], a[4:7], 0
    v_fma_f32 v124, v124, v250, v250
    v_fma_f32 v125, v125, v250, v250
    v_fma_f32 v126, v126, v250, v250
    v_fma_f32 v127, v127, v250, v250
    v_mfma_f32_16x16x32_bf16 v[148:151], v[40:43], a[12:15], v[148:151]
    v_rcp_f32 v124, v124
    v_rcp_f32 v125, v125
    v_mfma_f32_16x16x32_bf16 v[152:155], v[28:31], a[0:3], 0
    buffer_load_dwordx4 a[92:95], v3, s[60:63], s80 offen offset:256 sc1
    v_rcp_f32 v126, v126
    v_add_u32 v224, s20, v254
    v_mfma_f32_16x16x32_bf16 v[152:155], v[44:47], a[8:11], v[152:155]
    s_xor_b32 s20, s3, 2
    v_rcp_f32 v127, v127
    v_mul_f32 v176, v176, v184
    v_mul_f32 v177, v177, v185
    v_mfma_f32_16x16x32_bf16 v[156:159], v[28:31], a[4:7], 0
    s_waitcnt vmcnt(18)
    v_accvgpr_read_b32 v244, a16
    v_accvgpr_read_b32 v245, a20
    v_mul_f32 v178, v178, v186
    v_mul_f32_e64 v179, v179, v187
    v_mfma_f32_16x16x32_bf16 v[156:159], v[44:47], a[12:15], v[156:159]
    buffer_load_dwordx4 a[96:99], v3, s[60:63], s80 offen offset:2048 sc1
    v_accvgpr_read_b32 v246, a24
    v_accvgpr_read_b32 v247, a28
    v_mul_f32 v176, v176, v124
    v_mfma_f32_16x16x32_bf16 v[128:131], v[16:19], a[0:3], 0
    s_mul_i32 s20, s20, 6144
    v_max3_u32 v252, v244, v245, v246
    v_max_u32 v252, v252, v247
    v_mul_f32 v177, v177, v125
    v_mul_f32 v178, v178, v126
    v_mfma_f32_16x16x32_bf16 v[128:131], v[32:35], a[8:11], v[128:131]
    v_cmp_eq_u32 vcc, -1, v252
    v_mul_f32 v179, v179, v127
    s_add_u32 s6, s78, 401408
    v_cvt_pk_bf16_f32 v120, v176, v177
    v_mfma_f32_16x16x32_bf16 v[132:135], v[16:19], a[4:7], 0
    buffer_load_dwordx4 a[100:103], v3, s[60:63], s80 offen offset:2304 sc1
    v_cvt_pk_bf16_f32 v121, v178, v179
    v_fmac_f32 v180, v248, v212
    v_fmac_f32 v181, v248, v213
    v_mfma_f32_16x16x32_bf16 v[132:135], v[32:35], a[12:15], v[132:135]
Lc_54:
    s_cbranch_vccnz Lr_55
Lk_56:
    v_fmac_f32 v182, v248, v214
    v_fmac_f32 v183, v248, v215
    v_mul_f32 v124, v249, v180
    v_mfma_f32_16x16x32_bf16 v[136:139], v[52:55], a[16:19], v[136:139]
    s_add_u32 s80, s79, 69632
    buffer_load_dwordx4 a[104:107], v3, s[60:63], s80 offen offset:0 sc1
    v_mul_f32 v125, v249, v181
    v_mul_f32 v126, v249, v182
    v_mfma_f32_16x16x32_bf16 v[136:139], v[68:71], a[24:27], v[136:139]
    v_mul_f32 v127, v249, v183
    v_exp_f32 v124, v124
    v_add_u32 v225, s20, v254
    v_mfma_f32_16x16x32_bf16 v[140:143], v[52:55], a[20:23], v[140:143]
    s_xor_b32 s20, s3, 3
    v_exp_f32 v125, v125
    v_exp_f32 v126, v126
    v_mfma_f32_16x16x32_bf16 v[140:143], v[68:71], a[28:31], v[140:143]
    buffer_load_dwordx4 a[108:111], v3, s[60:63], s80 offen offset:256 sc1
    v_exp_f32 v127, v127
    v_fmac_f32 v188, v248, v220
    v_mfma_f32_16x16x32_bf16 v[144:147], v[56:59], a[16:19], v[144:147]
    s_mul_i32 s20, s20, 6144
    v_fmac_f32 v189, v248, v221
    v_fmac_f32 v190, v248, v222
    v_fmac_f32_e64 v191, v248, v223
    v_fma_f32 v124, v124, v250, v250
    v_mfma_f32_16x16x32_bf16 v[144:147], v[72:75], a[24:27], v[144:147]
    v_fma_f32 v125, v125, v250, v250
    v_fma_f32 v126, v126, v250, v250
    v_fma_f32 v127, v127, v250, v250
    v_add_u32 v226, s20, v254
    v_mfma_f32_16x16x32_bf16 v[148:151], v[56:59], a[20:23], v[148:151]
    s_mul_i32 s20, s3, 6144
    v_rcp_f32 v124, v124
    v_rcp_f32 v125, v125
    v_mfma_f32_16x16x32_bf16 v[148:151], v[72:75], a[28:31], v[148:151]
    v_rcp_f32 v126, v126
    v_rcp_f32 v127, v127
    v_mfma_f32_16x16x32_bf16 v[152:155], v[60:63], a[16:19], v[152:155]
    v_mul_f32 v180, v180, v188
    v_mul_f32 v181, v181, v189
    v_mul_f32 v182, v182, v190
    v_mul_f32 v183, v183, v191
    v_mfma_f32_16x16x32_bf16 v[152:155], v[76:79], a[24:27], v[152:155]
    v_mul_f32 v180, v180, v124
    v_mul_f32 v181, v181, v125
    v_mul_f32 v182, v182, v126
    v_mul_f32 v183, v183, v127
    v_mfma_f32_16x16x32_bf16 v[156:159], v[60:63], a[20:23], v[156:159]
    s_waitcnt vmcnt(18)
    v_accvgpr_read_b32 v244, a32
    v_accvgpr_read_b32 v245, a36
    v_cvt_pk_bf16_f32 v122, v180, v181
    v_cvt_pk_bf16_f32 v123, v182, v183
    v_mfma_f32_16x16x32_bf16 v[156:159], v[76:79], a[28:31], v[156:159]
    buffer_store_dwordx4 v[120:123], v2, s[60:63], s6 offen sc1
    v_accvgpr_read_b32 v246, a40
    v_accvgpr_read_b32 v247, a44
    v_add_u32 v227, s20, v254
    v_mfma_f32_16x16x32_bf16 v[128:131], v[48:51], a[16:19], v[128:131]
    v_max3_u32 v252, v244, v245, v246
    v_max_u32_e64 v252, v252, v247
    v_mfma_f32_16x16x32_bf16 v[128:131], v[64:67], a[24:27], v[128:131]
    v_cmp_eq_u32 vcc, -1, v252
    v_mul_u32_u24 v5, 896, v8
    v_mfma_f32_16x16x32_bf16 v[132:135], v[48:51], a[20:23], v[132:135]
    v_lshl_add_u32 v5, v7, 4, v5
    v_and_b32 v4, 0x3ff, v3
    v_mfma_f32_16x16x32_bf16 v[132:135], v[64:67], a[28:31], v[132:135]
Lc_57:
    s_cbranch_vccnz Lr_58
Lk_59:
    v_lshl_add_u32 v4, v7, 3, v4
    v_mfma_f32_16x16x32_bf16 v[136:139], v[84:87], a[32:35], v[136:139]
    s_barrier
    v_mfma_f32_16x16x32_bf16 v[136:139], v[100:103], a[40:43], v[136:139]
    buffer_load_dwordx2 v[228:229], v4, s[60:63], s77 offen sc1
    v_mfma_f32_16x16x32_bf16 v[140:143], v[84:87], a[36:39], v[140:143]
    buffer_load_dwordx2 v[230:231], v4, s[60:63], s77 offen offset:256 sc1
    s_add_u32 s77, s77, 57344
    v_mfma_f32_16x16x32_bf16 v[140:143], v[100:103], a[44:47], v[140:143]
    v_mfma_f32_16x16x32_bf16 v[144:147], v[88:91], a[32:35], v[144:147]
    v_mfma_f32_16x16x32_bf16 v[144:147], v[104:107], a[40:43], v[144:147]
    v_mfma_f32_16x16x32_bf16 v[148:151], v[88:91], a[36:39], v[148:151]
    v_mfma_f32_16x16x32_bf16 v[148:151], v[104:107], a[44:47], v[148:151]
    v_mfma_f32_16x16x32_bf16 v[152:155], v[92:95], a[32:35], v[152:155]
    v_mfma_f32_16x16x32_bf16 v[152:155], v[108:111], a[40:43], v[152:155]
    v_mfma_f32_16x16x32_bf16 v[156:159], v[92:95], a[36:39], v[156:159]
    s_waitcnt vmcnt(16)
    v_accvgpr_read_b32 v244, a48
    v_accvgpr_read_b32 v245, a52
    v_mfma_f32_16x16x32_bf16 v[156:159], v[108:111], a[44:47], v[156:159]
    v_accvgpr_read_b32 v246, a56
    v_accvgpr_read_b32 v247, a60
    v_mfma_f32_16x16x32_bf16 v[128:131], v[80:83], a[32:35], v[128:131]
    v_max3_u32 v252, v244, v245, v246
    v_max_u32 v252, v252, v247
    v_mfma_f32_16x16x32_bf16 v[128:131], v[96:99], a[40:43], v[128:131]
    v_cmp_eq_u32 vcc, -1, v252
    v_mfma_f32_16x16x32_bf16 v[132:135], v[80:83], a[36:39], v[132:135]
    v_mfma_f32_16x16x32_bf16 v[132:135], v[96:99], a[44:47], v[132:135]
Lc_60:
    s_cbranch_vccnz Lr_61
Lk_62:
    v_mfma_f32_16x16x32_bf16 v[136:139], a[228:231], a[48:51], v[136:139]
    v_mfma_f32_16x16x32_bf16 v[136:139], a[244:247], a[56:59], v[136:139]
    v_mfma_f32_16x16x32_bf16 v[140:143], a[228:231], a[52:55], v[140:143]
    v_mfma_f32_16x16x32_bf16 v[140:143], a[244:247], a[60:63], v[140:143]
    v_mfma_f32_16x16x32_bf16 v[144:147], a[232:235], a[48:51], v[144:147]
    s_add_u32 s80, s79, 229376
    buffer_load_dwordx4 a[0:3], v3, s[60:63], s80 offen offset:0 sc1
    v_mfma_f32_16x16x32_bf16 v[144:147], a[248:251], a[56:59], v[144:147]
    v_mfma_f32_16x16x32_bf16 v[148:151], a[232:235], a[52:55], v[148:151]
    v_mfma_f32_16x16x32_bf16 v[148:151], a[248:251], a[60:63], v[148:151]
    v_mfma_f32_16x16x32_bf16 v[152:155], a[236:239], a[48:51], v[152:155]
    buffer_load_dwordx4 a[4:7], v3, s[60:63], s80 offen offset:256 sc1
    v_mfma_f32_16x16x32_bf16 v[152:155], a[252:255], a[56:59], v[152:155]
    v_mfma_f32_16x16x32_bf16 v[156:159], a[236:239], a[52:55], v[156:159]
    s_waitcnt vmcnt(14)
    v_accvgpr_read_b32 v244, a64
    v_accvgpr_read_b32 v245, a68
    v_mfma_f32_16x16x32_bf16 v[156:159], a[252:255], a[60:63], v[156:159]
    v_accvgpr_read_b32 v246, a72
    v_accvgpr_read_b32 v247, a76
    v_mfma_f32_16x16x32_bf16 v[128:131], a[224:227], a[48:51], v[128:131]
    buffer_load_dwordx4 a[8:11], v3, s[60:63], s80 offen offset:2048 sc1
    v_max3_u32 v252, v244, v245, v246
    v_max_u32 v252, v252, v247
    v_mfma_f32_16x16x32_bf16 v[128:131], a[240:243], a[56:59], v[128:131]
    v_cmp_eq_u32 vcc, -1, v252
    v_mfma_f32_16x16x32_bf16 v[132:135], a[224:227], a[52:55], v[132:135]
    v_mfma_f32_16x16x32_bf16 v[132:135], a[240:243], a[60:63], v[132:135]
Lc_63:
    s_cbranch_vccnz Lr_64
Lk_65:
    v_mfma_f32_16x16x32_bf16 v[136:139], a[116:119], a[64:67], v[136:139]
    buffer_load_dwordx4 a[12:15], v3, s[60:63], s80 offen offset:2304 sc1
    v_mfma_f32_16x16x32_bf16 v[136:139], a[132:135], a[72:75], v[136:139]
    v_mfma_f32_16x16x32_bf16 v[140:143], a[116:119], a[68:71], v[140:143]
    v_mfma_f32_16x16x32_bf16 v[140:143], a[132:135], a[76:79], v[140:143]
    v_mfma_f32_16x16x32_bf16 v[144:147], a[120:123], a[64:67], v[144:147]
    s_add_u32 s80, s79, 233472
    buffer_load_dwordx4 a[16:19], v3, s[60:63], s80 offen offset:0 sc1
    v_mfma_f32_16x16x32_bf16 v[144:147], a[136:139], a[72:75], v[144:147]
    v_mfma_f32_16x16x32_bf16 v[148:151], a[120:123], a[68:71], v[148:151]
    v_mfma_f32_16x16x32_bf16 v[148:151], a[136:139], a[76:79], v[148:151]
    v_mfma_f32_16x16x32_bf16 v[152:155], a[124:127], a[64:67], v[152:155]
    buffer_load_dwordx4 a[20:23], v3, s[60:63], s80 offen offset:256 sc1
    v_mfma_f32_16x16x32_bf16 v[152:155], a[140:143], a[72:75], v[152:155]
L_pb3:
    s_cbranch_execz L_wr_r
    v_mfma_f32_16x16x32_bf16 v[156:159], a[124:127], a[68:71], v[156:159]
    s_waitcnt vmcnt(13)
    v_accvgpr_read_b32 v244, a80
    v_accvgpr_read_b32 v245, a84
    v_mfma_f32_16x16x32_bf16 v[156:159], a[140:143], a[76:79], v[156:159]
    v_accvgpr_read_b32 v246, a88
    v_accvgpr_read_b32 v247, a92
    v_mfma_f32_16x16x32_bf16 v[128:131], a[112:115], a[64:67], v[128:131]
    buffer_load_dwordx4 a[24:27], v3, s[60:63], s80 offen offset:2048 sc1
    v_max3_u32 v252, v244, v245, v246
    v_max_u32_e64 v252, v252, v247
    v_mfma_f32_16x16x32_bf16 v[128:131], a[128:131], a[72:75], v[128:131]
    v_cmp_eq_u32 vcc, -1, v252
    v_mfma_f32_16x16x32_bf16 v[132:135], a[112:115], a[68:71], v[132:135]
    v_mfma_f32_16x16x32_bf16 v[132:135], a[128:131], a[76:79], v[132:135]
Lc_66:
    s_cbranch_vccnz Lr_67
Lk_68:
    v_mfma_f32_16x16x32_bf16 v[136:139], a[148:151], a[80:83], v[136:139]
    buffer_load_dwordx4 a[28:31], v3, s[60:63], s80 offen offset:2304 sc1
    v_mfma_f32_16x16x32_bf16 v[136:139], a[164:167], a[88:91], v[136:139]
    v_mfma_f32_16x16x32_bf16 v[140:143], a[148:151], a[84:87], v[140:143]
    v_mfma_f32_16x16x32_bf16 v[140:143], a[164:167], a[92:95], v[140:143]
    v_mfma_f32_16x16x32_bf16 v[144:147], a[152:155], a[80:83], v[144:147]
    s_add_u32 s80, s79, 237568
    buffer_load_dwordx4 a[32:35], v3, s[60:63], s80 offen offset:0 sc1
    v_mfma_f32_16x16x32_bf16 v[144:147], a[168:171], a[88:91], v[144:147]
    v_mfma_f32_16x16x32_bf16 v[148:151], a[152:155], a[84:87], v[148:151]
    v_mfma_f32_16x16x32_bf16 v[148:151], a[168:171], a[92:95], v[148:151]
    v_mfma_f32_16x16x32_bf16 v[152:155], a[156:159], a[80:83], v[152:155]
    buffer_load_dwordx4 a[36:39], v3, s[60:63], s80 offen offset:256 sc1
    v_mfma_f32_16x16x32_bf16 v[152:155], a[172:175], a[88:91], v[152:155]
    v_mfma_f32_16x16x32_bf16 v[156:159], a[156:159], a[84:87], v[156:159]
    s_waitcnt vmcnt(13)
    v_accvgpr_read_b32 v244, a96
    v_accvgpr_read_b32 v245, a100
    v_mfma_f32_16x16x32_bf16 v[156:159], a[172:175], a[92:95], v[156:159]
    v_accvgpr_read_b32 v246, a104
    v_accvgpr_read_b32 v247, a108
    v_mfma_f32_16x16x32_bf16 v[128:131], a[144:147], a[80:83], v[128:131]
    buffer_load_dwordx4 a[40:43], v3, s[60:63], s80 offen offset:2048 sc1
    v_max3_u32 v252, v244, v245, v246
    v_max_u32 v252, v252, v247
    v_mfma_f32_16x16x32_bf16 v[128:131], a[160:163], a[88:91], v[128:131]
    v_cmp_eq_u32 vcc, -1, v252
    v_mfma_f32_16x16x32_bf16 v[132:135], a[144:147], a[84:87], v[132:135]
    v_mfma_f32_16x16x32_bf16 v[132:135], a[160:163], a[92:95], v[132:135]
Lc_69:
    s_cbranch_vccnz Lr_70
Lk_71:
    v_mfma_f32_16x16x32_bf16 v[136:139], a[180:183], a[96:99], v[136:139]
    buffer_load_dwordx4 a[44:47], v3, s[60:63], s80 offen offset:2304 sc1
    v_mfma_f32_16x16x32_bf16 v[136:139], a[196:199], a[104:107], v[136:139]
    s_waitcnt vmcnt(12)
    v_lshlrev_b32 v216, 16, v228
    v_and_b32 v217, s71, v228
    v_mfma_f32_16x16x32_bf16 v[140:143], a[180:183], a[100:103], v[140:143]
    v_lshlrev_b32 v218, 16, v229
    v_and_b32 v219, s71, v229
    v_mfma_f32_16x16x32_bf16 v[140:143], a[196:199], a[108:111], v[140:143]
    v_lshlrev_b32 v220, 16, v230
    v_and_b32_e64 v221, s71, v230
    v_mfma_f32_16x16x32_bf16 v[144:147], a[184:187], a[96:99], v[144:147]
    s_add_u32 s80, s79, 241664
    buffer_load_dwordx4 a[48:51], v3, s[60:63], s80 offen offset:0 sc1
    v_mfma_f32_16x16x32_bf16 v[144:147], a[200:203], a[104:107], v[144:147]
    v_lshlrev_b32 v222, 16, v231
    v_and_b32 v223, s71, v231
    v_mfma_f32_16x16x32_bf16 v[148:151], a[184:187], a[100:103], v[148:151]
    v_mfma_f32_16x16x32_bf16 v[148:151], a[200:203], a[108:111], v[148:151]
    v_mfma_f32_16x16x32_bf16 v[152:155], a[188:191], a[96:99], v[152:155]
    buffer_load_dwordx4 a[52:55], v3, s[60:63], s80 offen offset:256 sc1
    v_mfma_f32_16x16x32_bf16 v[152:155], a[204:207], a[104:107], v[152:155]
    v_mfma_f32_16x16x32_bf16 v[156:159], a[188:191], a[100:103], v[156:159]
    s_waitcnt vmcnt(10)
    v_accvgpr_read_b32 v244, a0
    v_accvgpr_read_b32 v245, a4
    v_mfma_f32_16x16x32_bf16 v[156:159], a[204:207], a[108:111], v[156:159]
    v_accvgpr_read_b32 v246, a8
    v_accvgpr_read_b32 v247, a12
    v_mfma_f32_16x16x32_bf16 v[128:131], a[176:179], a[96:99], v[128:131]
    s_add_u32 s80, s79, 286720
    buffer_load_dwordx4 a[56:59], v3, s[60:63], s80 offen offset:0 sc1
    v_max3_u32 v252, v244, v245, v246
    v_max_u32 v252, v252, v247
    v_mfma_f32_16x16x32_bf16 v[128:131], a[192:195], a[104:107], v[128:131]
    v_cmp_eq_u32 vcc, -1, v252
    v_mfma_f32_16x16x32_bf16 v[132:135], a[176:179], a[100:103], v[132:135]
    v_mfma_f32_16x16x32_bf16 v[132:135], a[192:195], a[108:111], v[132:135]
Lc_72:
    s_cbranch_vccnz Lr_73
Lk_74:
    v_mfma_f32_16x16x32_bf16 v[168:171], v[20:23], a[0:3], 0
    buffer_load_dwordx4 a[60:63], v3, s[60:63], s80 offen offset:256 sc1
    v_mfma_f32_16x16x32_bf16 v[168:171], v[36:39], a[8:11], v[168:171]
    buffer_load_dwordx2 v[232:233], v4, s[60:63], s77 offen sc1
    v_mfma_f32_16x16x32_bf16 v[172:175], v[20:23], a[4:7], 0
    buffer_load_dwordx2 v[234:235], v4, s[60:63], s77 offen offset:256 sc1
    v_mfma_f32_16x16x32_bf16 v[172:175], v[36:39], a[12:15], v[172:175]
    ds_write_b128 v224, v[136:139] offset:0
    v_mfma_f32_16x16x32_bf16 v[176:179], v[24:27], a[0:3], 0
    buffer_load_dwordx4 a[64:67], v3, s[60:63], s80 offen offset:2048 sc1
    v_mfma_f32_16x16x32_bf16 v[176:179], v[40:43], a[8:11], v[176:179]
    ds_write_b128 v224, v[140:143] offset:1024
    v_mfma_f32_16x16x32_bf16 v[180:183], v[24:27], a[4:7], 0
    v_mfma_f32_16x16x32_bf16 v[180:183], v[40:43], a[12:15], v[180:183]
    v_mfma_f32_16x16x32_bf16 v[184:187], v[28:31], a[0:3], 0
    buffer_load_dwordx4 a[68:71], v3, s[60:63], s80 offen offset:2304 sc1
    v_mfma_f32_16x16x32_bf16 v[184:187], v[44:47], a[8:11], v[184:187]
    ds_write_b128 v225, v[144:147] offset:2048
    v_mfma_f32_16x16x32_bf16 v[188:191], v[28:31], a[4:7], 0
    s_waitcnt vmcnt(12)
    v_accvgpr_read_b32 v244, a16
    v_accvgpr_read_b32 v245, a20
    v_mfma_f32_16x16x32_bf16 v[188:191], v[44:47], a[12:15], v[188:191]
    v_accvgpr_read_b32 v246, a24
    v_accvgpr_read_b32 v247, a28
    v_mfma_f32_16x16x32_bf16 v[160:163], v[16:19], a[0:3], 0
    s_add_u32 s80, s79, 290816
    buffer_load_dwordx4 a[72:75], v3, s[60:63], s80 offen offset:0 sc1
    v_max3_u32 v252, v244, v245, v246
    v_max_u32 v252, v252, v247
    v_mfma_f32_16x16x32_bf16 v[160:163], v[32:35], a[8:11], v[160:163]
    ds_write_b128 v225, v[148:151] offset:3072
    v_cmp_eq_u32 vcc, -1, v252
    v_mfma_f32_16x16x32_bf16 v[164:167], v[16:19], a[4:7], 0
    v_mfma_f32_16x16x32_bf16 v[164:167], v[32:35], a[12:15], v[164:167]
Lc_75:
    s_cbranch_vccnz Lr_76
Lk_77:
    v_mfma_f32_16x16x32_bf16 v[168:171], v[52:55], a[16:19], v[168:171]
    buffer_load_dwordx4 a[76:79], v3, s[60:63], s80 offen offset:256 sc1
    v_mfma_f32_16x16x32_bf16 v[168:171], v[68:71], a[24:27], v[168:171]
    ds_write_b128 v226, v[152:155] offset:4096
    v_mfma_f32_16x16x32_bf16 v[172:175], v[52:55], a[20:23], v[172:175]
    v_mfma_f32_16x16x32_bf16 v[172:175], v[68:71], a[28:31], v[172:175]
    v_mfma_f32_16x16x32_bf16 v[176:179], v[56:59], a[16:19], v[176:179]
    buffer_load_dwordx4 a[80:83], v3, s[60:63], s80 offen offset:2048 sc1
    v_mfma_f32_16x16x32_bf16 v[176:179], v[72:75], a[24:27], v[176:179]
    ds_write_b128 v226, v[156:159] offset:5120
    v_mfma_f32_16x16x32_bf16 v[180:183], v[56:59], a[20:23], v[180:183]
    v_mfma_f32_16x16x32_bf16 v[180:183], v[72:75], a[28:31], v[180:183]
    v_mfma_f32_16x16x32_bf16 v[184:187], v[60:63], a[16:19], v[184:187]
    buffer_load_dwordx4 a[84:87], v3, s[60:63], s80 offen offset:2304 sc1
    v_mfma_f32_16x16x32_bf16 v[184:187], v[76:79], a[24:27], v[184:187]
    v_mfma_f32_16x16x32_bf16 v[188:191], v[60:63], a[20:23], v[188:191]
    s_waitcnt vmcnt(12)
    v_accvgpr_read_b32 v244, a32
    v_accvgpr_read_b32 v245, a36
    v_mfma_f32_16x16x32_bf16 v[188:191], v[76:79], a[28:31], v[188:191]
    v_accvgpr_read_b32 v246, a40
    v_accvgpr_read_b32 v247, a44
    v_mfma_f32_16x16x32_bf16 v[160:163], v[48:51], a[16:19], v[160:163]
    s_add_u32 s80, s79, 294912
    buffer_load_dwordx4 a[88:91], v3, s[60:63], s80 offen offset:0 sc1
    v_max3_u32 v252, v244, v245, v246
    v_max_u32 v252, v252, v247
    v_mfma_f32_16x16x32_bf16 v[160:163], v[64:67], a[24:27], v[160:163]
    v_cmp_eq_u32 vcc, -1, v252
    v_mfma_f32_16x16x32_bf16 v[164:167], v[48:51], a[20:23], v[164:167]
    v_mfma_f32_16x16x32_bf16 v[164:167], v[64:67], a[28:31], v[164:167]
    s_waitcnt lgkmcnt(0)
Lc_78:
    s_cbranch_vccnz Lr_79
Lk_80:
    v_mfma_f32_16x16x32_bf16 v[168:171], v[84:87], a[32:35], v[168:171]
    buffer_load_dwordx4 a[92:95], v3, s[60:63], s80 offen offset:256 sc1
    v_mfma_f32_16x16x32_bf16 v[168:171], v[100:103], a[40:43], v[168:171]
    s_barrier
    v_mfma_f32_16x16x32_bf16 v[172:175], v[84:87], a[36:39], v[172:175]
    ds_read_b128 v[192:195], v227 offset:0
    v_mfma_f32_16x16x32_bf16 v[172:175], v[100:103], a[44:47], v[172:175]
    ds_read_b128 v[196:199], v227 offset:1024
    v_mfma_f32_16x16x32_bf16 v[176:179], v[88:91], a[32:35], v[176:179]
    buffer_load_dwordx4 a[96:99], v3, s[60:63], s80 offen offset:2048 sc1
    ds_read_b128 v[200:203], v227 offset:2048
    v_mfma_f32_16x16x32_bf16 v[176:179], v[104:107], a[40:43], v[176:179]
    ds_read_b128 v[204:207], v227 offset:3072
    v_mfma_f32_16x16x32_bf16 v[180:183], v[88:91], a[36:39], v[180:183]
    ds_read_b128 v[208:211], v227 offset:4096
    v_mfma_f32_16x16x32_bf16 v[180:183], v[104:107], a[44:47], v[180:183]
    ds_read_b128 v[212:215], v227 offset:5120
    v_add_f32 v216, v216, v128
    v_mfma_f32_16x16x32_bf16 v[184:187], v[92:95], a[32:35], v[184:187]
    buffer_load_dwordx4 a[100:103], v3, s[60:63], s80 offen offset:2304 sc1
    v_add_f32 v217, v217, v129
    v_mfma_f32_16x16x32_bf16 v[184:187], v[108:111], a[40:43], v[184:187]
    v_add_f32 v218, v218, v130
    v_add_f32_e64 v219, v219, v131
    v_mfma_f32_16x16x32_bf16 v[188:191], v[92:95], a[36:39], v[188:191]
    s_waitcnt vmcnt(12)
    v_accvgpr_read_b32 v244, a48
    v_accvgpr_read_b32 v245, a52
    v_mfma_f32_16x16x32_bf16 v[188:191], v[108:111], a[44:47], v[188:191]
    v_accvgpr_read_b32 v246, a56
    v_accvgpr_read_b32 v247, a60
    v_mfma_f32_16x16x32_bf16 v[160:163], v[80:83], a[32:35], v[160:163]
    s_add_u32 s80, s79, 299008
    buffer_load_dwordx4 a[104:107], v3, s[60:63], s80 offen offset:0 sc1
    v_max3_u32 v252, v244, v245, v246
    v_max_u32 v252, v252, v247
    v_mfma_f32_16x16x32_bf16 v[160:163], v[96:99], a[40:43], v[160:163]
    v_cmp_eq_u32 vcc, -1, v252
    v_add_f32 v220, v220, v132
    v_mfma_f32_16x16x32_bf16 v[164:167], v[80:83], a[36:39], v[164:167]
    v_add_f32 v221, v221, v133
    v_add_f32 v222, v222, v134
    v_mfma_f32_16x16x32_bf16 v[164:167], v[96:99], a[44:47], v[164:167]
Lc_81:
    s_cbranch_vccnz Lr_82
Lk_83:
    v_add_f32 v223, v223, v135
    v_mfma_f32_16x16x32_bf16 v[168:171], a[228:231], a[48:51], v[168:171]
    s_waitcnt lgkmcnt(4)
    buffer_load_dwordx4 a[108:111], v3, s[60:63], s80 offen offset:256 sc1
    v_add_f32 v216, v216, v192
    v_mfma_f32_16x16x32_bf16 v[168:171], a[244:247], a[56:59], v[168:171]
    v_add_f32 v217, v217, v193
    v_add_f32 v218, v218, v194
    v_mfma_f32_16x16x32_bf16 v[172:175], a[228:231], a[52:55], v[172:175]
    v_add_f32 v219, v219, v195
    v_add_f32 v220, v220, v196
    v_mfma_f32_16x16x32_bf16 v[172:175], a[244:247], a[60:63], v[172:175]
    v_add_f32 v221, v221, v197
    v_add_f32 v222, v222, v198
    v_mfma_f32_16x16x32_bf16 v[176:179], a[232:235], a[48:51], v[176:179]
    v_add_f32 v223, v223, v199
    s_waitcnt lgkmcnt(2)
    v_mfma_f32_16x16x32_bf16 v[176:179], a[248:251], a[56:59], v[176:179]
    v_add_f32 v216, v216, v200
    v_add_f32 v217, v217, v201
    v_mfma_f32_16x16x32_bf16 v[180:183], a[232:235], a[52:55], v[180:183]
    v_add_f32 v218, v218, v202
    v_add_f32 v219, v219, v203
    v_mfma_f32_16x16x32_bf16 v[180:183], a[248:251], a[60:63], v[180:183]
    v_add_f32 v220, v220, v204
    v_add_f32 v221, v221, v205
    v_mfma_f32_16x16x32_bf16 v[184:187], a[236:239], a[48:51], v[184:187]
    v_add_f32 v222, v222, v206
    v_add_f32 v223, v223, v207
    v_mfma_f32_16x16x32_bf16 v[184:187], a[252:255], a[56:59], v[184:187]
    s_waitcnt lgkmcnt(0)
    v_add_f32 v216, v216, v208
    v_add_f32_e64 v217, v217, v209
    v_mfma_f32_16x16x32_bf16 v[188:191], a[236:239], a[52:55], v[188:191]
    s_waitcnt vmcnt(8)
    v_accvgpr_read_b32 v244, a64
    v_accvgpr_read_b32 v245, a68
    v_mfma_f32_16x16x32_bf16 v[188:191], a[252:255], a[60:63], v[188:191]
    v_accvgpr_read_b32 v246, a72
    v_accvgpr_read_b32 v247, a76
    v_mfma_f32_16x16x32_bf16 v[160:163], a[224:227], a[48:51], v[160:163]
    v_max3_u32 v252, v244, v245, v246
    v_max_u32 v252, v252, v247
    v_mfma_f32_16x16x32_bf16 v[160:163], a[240:243], a[56:59], v[160:163]
    v_cmp_eq_u32 vcc, -1, v252
    v_add_f32 v218, v218, v210
    v_mfma_f32_16x16x32_bf16 v[164:167], a[224:227], a[52:55], v[164:167]
    v_add_f32 v219, v219, v211
    v_add_f32 v220, v220, v212
    v_mfma_f32_16x16x32_bf16 v[164:167], a[240:243], a[60:63], v[164:167]
Lc_84:
    s_cbranch_vccnz Lr_85
Lk_86:
    v_add_f32 v221, v221, v213
    v_mfma_f32_16x16x32_bf16 v[168:171], a[116:119], a[64:67], v[168:171]
    v_add_f32 v222, v222, v214
    v_add_f32_e64 v223, v223, v215
    v_mfma_f32_16x16x32_bf16 v[168:171], a[132:135], a[72:75], v[168:171]
    v_cvt_pk_bf16_f32 v240, v216, v217
    v_cvt_pk_bf16_f32 v241, v218, v219
    v_mfma_f32_16x16x32_bf16 v[172:175], a[116:119], a[68:71], v[172:175]
    v_cvt_pk_bf16_f32 v242, v220, v221
    v_cvt_pk_bf16_f32 v243, v222, v223
    v_mfma_f32_16x16x32_bf16 v[172:175], a[132:135], a[76:79], v[172:175]
    v_permlane16_swap_b32 v240, v242
    v_mfma_f32_16x16x32_bf16 v[176:179], a[120:123], a[64:67], v[176:179]
    v_permlane16_swap_b32 v241, v243
    v_mfma_f32_16x16x32_bf16 v[176:179], a[136:139], a[72:75], v[176:179]
    buffer_store_dwordx4 v[240:243], v5, s[56:59], s76 offen
    s_add_u32 s76, s76, 57344
    v_mfma_f32_16x16x32_bf16 v[180:183], a[120:123], a[68:71], v[180:183]
    s_waitcnt vmcnt(5)
    v_accvgpr_read_b32 v244, a80
    v_accvgpr_read_b32 v245, a84
    v_mfma_f32_16x16x32_bf16 v[180:183], a[136:139], a[76:79], v[180:183]
    v_accvgpr_read_b32 v246, a88
    v_accvgpr_read_b32 v247, a92
    v_mfma_f32_16x16x32_bf16 v[184:187], a[124:127], a[64:67], v[184:187]
    v_max3_u32 v252, v244, v245, v246
    v_max_u32 v252, v252, v247
    v_mfma_f32_16x16x32_bf16 v[184:187], a[140:143], a[72:75], v[184:187]
    v_cmp_eq_u32 vcc, -1, v252
    v_lshlrev_b32 v216, 16, v232
    v_mfma_f32_16x16x32_bf16 v[188:191], a[124:127], a[68:71], v[188:191]
    v_and_b32 v217, s71, v232
    v_lshlrev_b32 v218, 16, v233
    v_mfma_f32_16x16x32_bf16 v[188:191], a[140:143], a[76:79], v[188:191]
Lc_87:
    s_cbranch_vccnz Lr_88
Lk_89:
    v_and_b32 v219, s71, v233
    v_mfma_f32_16x16x32_bf16 v[168:171], a[148:151], a[80:83], v[168:171]
    v_lshlrev_b32 v220, 16, v234
    v_and_b32 v221, s71, v234
    v_mfma_f32_16x16x32_bf16 v[168:171], a[164:167], a[88:91], v[168:171]
    v_lshlrev_b32 v222, 16, v235
    v_and_b32 v223, s71, v235
    v_mfma_f32_16x16x32_bf16 v[172:175], a[148:151], a[84:87], v[172:175]
    v_mfma_f32_16x16x32_bf16 v[172:175], a[164:167], a[92:95], v[172:175]
    v_mfma_f32_16x16x32_bf16 v[176:179], a[152:155], a[80:83], v[176:179]
    v_mfma_f32_16x16x32_bf16 v[176:179], a[168:171], a[88:91], v[176:179]
    v_mfma_f32_16x16x32_bf16 v[180:183], a[152:155], a[84:87], v[180:183]
    s_waitcnt vmcnt(1)
    v_accvgpr_read_b32 v244, a96
    v_accvgpr_read_b32 v245, a100
    v_mfma_f32_16x16x32_bf16 v[180:183], a[168:171], a[92:95], v[180:183]
    v_accvgpr_read_b32 v246, a104
    v_accvgpr_read_b32 v247, a108
    v_mfma_f32_16x16x32_bf16 v[184:187], a[156:159], a[80:83], v[184:187]
    v_max3_u32 v252, v244, v245, v246
    v_max_u32 v252, v252, v247
    v_mfma_f32_16x16x32_bf16 v[184:187], a[172:175], a[88:91], v[184:187]
    v_cmp_eq_u32 vcc, -1, v252
    v_mfma_f32_16x16x32_bf16 v[188:191], a[156:159], a[84:87], v[188:191]
    v_mfma_f32_16x16x32_bf16 v[188:191], a[172:175], a[92:95], v[188:191]
Lc_90:
    s_cbranch_vccnz Lr_91
Lk_92:
    v_mfma_f32_16x16x32_bf16 v[168:171], a[180:183], a[96:99], v[168:171]
    v_mfma_f32_16x16x32_bf16 v[168:171], a[196:199], a[104:107], v[168:171]
    v_mfma_f32_16x16x32_bf16 v[172:175], a[180:183], a[100:103], v[172:175]
    v_mfma_f32_16x16x32_bf16 v[172:175], a[196:199], a[108:111], v[172:175]
    v_mfma_f32_16x16x32_bf16 v[176:179], a[184:187], a[96:99], v[176:179]
    v_mfma_f32_16x16x32_bf16 v[176:179], a[200:203], a[104:107], v[176:179]
    s_nop 3
    ds_write_b128 v224, v[168:171] offset:32768
    v_mfma_f32_16x16x32_bf16 v[180:183], a[184:187], a[100:103], v[180:183]
    v_mfma_f32_16x16x32_bf16 v[180:183], a[200:203], a[108:111], v[180:183]
    ds_write_b128 v224, v[172:175] offset:33792
    v_mfma_f32_16x16x32_bf16 v[184:187], a[188:191], a[96:99], v[184:187]
    v_mfma_f32_16x16x32_bf16 v[184:187], a[204:207], a[104:107], v[184:187]
    ds_write_b128 v225, v[176:179] offset:34816
    v_mfma_f32_16x16x32_bf16 v[188:191], a[188:191], a[100:103], v[188:191]
    v_mfma_f32_16x16x32_bf16 v[188:191], a[204:207], a[108:111], v[188:191]
    s_nop 1
    ds_write_b128 v225, v[180:183] offset:35840
    v_mfma_f32_16x16x32_bf16 v[160:163], a[112:115], a[64:67], v[160:163]
    v_mfma_f32_16x16x32_bf16 v[160:163], a[128:131], a[72:75], v[160:163]
    ds_write_b128 v226, v[184:187] offset:36864
    v_mfma_f32_16x16x32_bf16 v[160:163], a[144:147], a[80:83], v[160:163]
    v_mfma_f32_16x16x32_bf16 v[160:163], a[160:163], a[88:91], v[160:163]
    ds_write_b128 v226, v[188:191] offset:37888
    v_mfma_f32_16x16x32_bf16 v[160:163], a[176:179], a[96:99], v[160:163]
    v_mfma_f32_16x16x32_bf16 v[160:163], a[192:195], a[104:107], v[160:163]
    v_mfma_f32_16x16x32_bf16 v[164:167], a[112:115], a[68:71], v[164:167]
    v_mfma_f32_16x16x32_bf16 v[164:167], a[128:131], a[76:79], v[164:167]
    v_mfma_f32_16x16x32_bf16 v[164:167], a[144:147], a[84:87], v[164:167]
    v_mfma_f32_16x16x32_bf16 v[164:167], a[160:163], a[92:95], v[164:167]
    s_waitcnt lgkmcnt(0)
    s_barrier
    v_mfma_f32_16x16x32_bf16 v[164:167], a[176:179], a[100:103], v[164:167]
    ds_read_b128 v[192:195], v227 offset:32768
    v_mfma_f32_16x16x32_bf16 v[164:167], a[192:195], a[108:111], v[164:167]
    ds_read_b128 v[196:199], v227 offset:33792
    ds_read_b128 v[200:203], v227 offset:34816
    ds_read_b128 v[204:207], v227 offset:35840
    ds_read_b128 v[208:211], v227 offset:36864
    ds_read_b128 v[212:215], v227 offset:37888
    v_pk_add_f32 v[216:217], v[216:217], v[160:161]
    v_pk_add_f32 v[218:219], v[218:219], v[162:163]
    s_nop 0
    v_pk_add_f32 v[220:221], v[220:221], v[164:165]
    v_pk_add_f32 v[222:223], v[222:223], v[166:167]
    s_waitcnt lgkmcnt(4)
    v_pk_add_f32 v[216:217], v[216:217], v[192:193]
    v_pk_add_f32 v[218:219], v[218:219], v[194:195]
    v_pk_add_f32 v[220:221], v[220:221], v[196:197]
    v_pk_add_f32 v[222:223], v[222:223], v[198:199]
    s_waitcnt lgkmcnt(2)
    v_pk_add_f32 v[216:217], v[216:217], v[200:201]
    v_pk_add_f32 v[218:219], v[218:219], v[202:203]
    v_pk_add_f32 v[220:221], v[220:221], v[204:205]
    v_pk_add_f32 v[222:223], v[222:223], v[206:207]
    s_waitcnt lgkmcnt(0)
    v_pk_add_f32 v[216:217], v[216:217], v[208:209]
    v_pk_add_f32 v[218:219], v[218:219], v[210:211]
    v_pk_add_f32 v[220:221], v[220:221], v[212:213]
    v_pk_add_f32 v[222:223], v[222:223], v[214:215]
    v_cvt_pk_bf16_f32 v240, v216, v217
    v_cvt_pk_bf16_f32 v241, v218, v219
    v_cvt_pk_bf16_f32 v242, v220, v221
    v_cvt_pk_bf16_f32 v243, v222, v223
    s_nop 0
    v_permlane16_swap_b32 v240, v242
    v_permlane16_swap_b32 v241, v243
    buffer_store_dwordx4 v[240:243], v5, s[56:59], s76 offen
    s_add_u32 s76, s76, 57344
    s_or_b32 s78, s2, s3
    s_cmp_lg_u32 s78, 0
    s_cbranch_scc1 L_fin
    buffer_store_dword v15, v14, s[60:63], 0 offen sc1
L_fin:
L_end:
    s_endpgm
Lr_4:
    s_cmp_eq_u32 s84, 0
    s_cbranch_scc1 Lk_5
    s_sub_u32 s84, s84, 1
    s_mov_b32 s19, m0
    s_nop 0
    s_add_u32 m0, s13, 57344
    s_add_u32 s49, s17, 4653056
    buffer_load_dwordx4 v2, s[60:63], s49 offen offset:0 sc1 lds
    buffer_load_dwordx4 v2, s[60:63], s49 offen offset:1024 sc1 lds
    buffer_load_dwordx4 v2, s[60:63], s49 offen offset:2048 sc1 lds
    buffer_load_dwordx4 v2, s[60:63], s49 offen offset:3072 sc1 lds
    s_add_u32 m0, s13, 61440
    s_add_u32 s49, s17, 4657152
    buffer_load_dwordx4 v2, s[60:63], s49 offen offset:0 sc1 lds
    buffer_load_dwordx4 v2, s[60:63], s49 offen offset:1024 sc1 lds
    buffer_load_dwordx4 v2, s[60:63], s49 offen offset:2048 sc1 lds
    buffer_load_dwordx4 v2, s[60:63], s49 offen offset:3072 sc1 lds
    s_add_u32 m0, s13, 65536
    s_add_u32 s49, s17, 4661248
    buffer_load_dwordx4 v2, s[60:63], s49 offen offset:0 sc1 lds
    buffer_load_dwordx4 v2, s[60:63], s49 offen offset:1024 sc1 lds
    s_add_u32 m0, s23, 98304
    s_add_u32 s49, s18, 4694016
    buffer_load_dwordx4 v2, s[60:63], s49 offen offset:0 sc1 lds
    buffer_load_dwordx4 v2, s[60:63], s49 offen offset:1024 sc1 lds
    buffer_load_dwordx4 v2, s[60:63], s49 offen offset:2048 sc1 lds
    buffer_load_dwordx4 v2, s[60:63], s49 offen offset:3072 sc1 lds
    s_mov_b32 m0, s19
    s_waitcnt vmcnt(0)
    ds_read2st64_b32 v[216:217], v1 offset0:0 offset1:4
    ds_read2st64_b32 v[218:219], v1 offset0:8 offset1:12
    ds_read2st64_b32 v[220:221], v1 offset0:16 offset1:20
    ds_read2st64_b32 v[222:223], v1 offset0:24 offset1:28
    ds_read2st64_b32 v[224:225], v1 offset0:32 offset1:36
    ds_read2st64_b32 v[226:227], v4 offset0:0 offset1:4
    ds_read2st64_b32 v[228:229], v4 offset0:8 offset1:12
    s_waitcnt lgkmcnt(0)
    s_waitcnt vmcnt(0)
    s_branch Lc_3
Lr_7:
    s_cmp_eq_u32 s84, 0
    s_cbranch_scc1 Lk_8
    s_sub_u32 s84, s84, 1
    s_mov_b32 s19, m0
    s_add_u32 m0, s13, 0
    s_add_u32 s49, s17, 4194304
    buffer_load_dwordx4 v2, s[60:63], s49 offen offset:0 sc1 lds
    buffer_load_dwordx4 v2, s[60:63], s49 offen offset:1024 sc1 lds
    buffer_load_dwordx4 v2, s[60:63], s49 offen offset:2048 sc1 lds
    buffer_load_dwordx4 v2, s[60:63], s49 offen offset:3072 sc1 lds
    s_add_u32 m0, s13, 4096
    s_add_u32 s49, s17, 4198400
    buffer_load_dwordx4 v2, s[60:63], s49 offen offset:0 sc1 lds
    buffer_load_dwordx4 v2, s[60:63], s49 offen offset:1024 sc1 lds
    buffer_load_dwordx4 v2, s[60:63], s49 offen offset:2048 sc1 lds
    buffer_load_dwordx4 v2, s[60:63], s49 offen offset:3072 sc1 lds
    s_add_u32 m0, s13, 8192
    s_add_u32 s49, s17, 4202496
    buffer_load_dwordx4 v2, s[60:63], s49 offen offset:0 sc1 lds
    buffer_load_dwordx4 v2, s[60:63], s49 offen offset:1024 sc1 lds
    s_add_u32 m0, s23, 40960
    s_add_u32 s49, s18, 4235264
    buffer_load_dwordx4 v2, s[60:63], s49 offen offset:0 sc1 lds
    buffer_load_dwordx4 v2, s[60:63], s49 offen offset:1024 sc1 lds
    buffer_load_dwordx4 v2, s[60:63], s49 offen offset:2048 sc1 lds
    buffer_load_dwordx4 v2, s[60:63], s49 offen offset:3072 sc1 lds
    s_mov_b32 m0, s19
    s_waitcnt vmcnt(0)
    ds_read2st64_b32 v[216:217], v1 offset0:0 offset1:4
    ds_read2st64_b32 v[218:219], v1 offset0:8 offset1:12
    ds_read2st64_b32 v[220:221], v1 offset0:16 offset1:20
    ds_read2st64_b32 v[222:223], v1 offset0:24 offset1:28
    ds_read2st64_b32 v[224:225], v1 offset0:32 offset1:36
    ds_read2st64_b32 v[226:227], v4 offset0:0 offset1:4
    ds_read2st64_b32 v[228:229], v4 offset0:8 offset1:12
    s_waitcnt lgkmcnt(0)
    s_waitcnt vmcnt(0)
    s_branch Lc_6
Lr_10:
    s_cmp_eq_u32 s84, 0
    s_cbranch_scc1 Lk_11
    s_sub_u32 s84, s84, 1
    buffer_load_dwordx4 v[176:179], v2, s[60:63], s6 offen offset:0 sc1
    buffer_load_dwordx4 v[180:183], v2, s[60:63], s6 offen offset:1024 sc1
    s_waitcnt vmcnt(0)
    s_branch Lc_9
Lr_13:
    s_cmp_eq_u32 s84, 0
    s_cbranch_scc1 Lk_14
    s_sub_u32 s84, s84, 1
    buffer_load_dwordx4 v[96:99], v2, s[60:63], s10 offen offset:0 sc1
    buffer_load_dwordx4 v[100:103], v2, s[60:63], s10 offen offset:1024 sc1
    buffer_load_dwordx4 v[104:107], v2, s[60:63], s10 offen offset:2048 sc1
    buffer_load_dwordx4 v[108:111], v2, s[60:63], s10 offen offset:3072 sc1
    s_waitcnt vmcnt(0)
    s_branch Lc_12
Lr_16:
    s_cmp_eq_u32 s84, 0
    s_cbranch_scc1 Lk_17
    s_sub_u32 s84, s84, 1
    s_add_u32 s82, s78, 0
    s_nop 0
    buffer_load_dwordx4 v[128:131], v2, s[60:63], s82 offen offset:0 sc1
    buffer_load_dwordx4 v[132:135], v2, s[60:63], s82 offen offset:1024 sc1
    s_add_u32 s82, s78, 139264
    buffer_load_dwordx4 v[136:139], v2, s[60:63], s82 offen offset:0 sc1
    buffer_load_dwordx4 v[140:143], v2, s[60:63], s82 offen offset:1024 sc1
    s_add_u32 s82, s78, 278528
    buffer_load_dwordx4 v[144:147], v2, s[60:63], s82 offen offset:0 sc1
    buffer_load_dwordx4 v[148:151], v2, s[60:63], s82 offen offset:1024 sc1
    s_add_u32 s82, s78, 417792
    buffer_load_dwordx4 v[152:155], v2, s[60:63], s82 offen offset:0 sc1
    buffer_load_dwordx4 v[156:159], v2, s[60:63], s82 offen offset:1024 sc1
    s_add_u32 s82, s78, 557056
    buffer_load_dwordx4 v[160:163], v2, s[60:63], s82 offen offset:0 sc1
    buffer_load_dwordx4 v[164:167], v2, s[60:63], s82 offen offset:1024 sc1
    s_add_u32 s82, s78, 696320
    buffer_load_dwordx4 v[168:171], v2, s[60:63], s82 offen offset:0 sc1
    buffer_load_dwordx4 v[172:175], v2, s[60:63], s82 offen offset:1024 sc1
    s_add_u32 s82, s78, 835584
    buffer_load_dwordx4 v[176:179], v2, s[60:63], s82 offen offset:0 sc1
    buffer_load_dwordx4 v[180:183], v2, s[60:63], s82 offen offset:1024 sc1
    s_add_u32 s82, s78, 974848
    buffer_load_dwordx4 v[184:187], v2, s[60:63], s82 offen offset:0 sc1
    buffer_load_dwordx4 v[188:191], v2, s[60:63], s82 offen offset:1024 sc1
    s_waitcnt vmcnt(0)
    s_branch Lc_15
Lr_19:
    s_cmp_eq_u32 s84, 0
    s_cbranch_scc1 Lk_20
    s_sub_u32 s84, s84, 1
    s_nop 0
    s_add_u32 s82, s78, 278528
    buffer_load_dwordx4 v[144:147], v2, s[60:63], s82 offen offset:0 sc1
    buffer_load_dwordx4 v[148:151], v2, s[60:63], s82 offen offset:1024 sc1
    s_add_u32 s82, s78, 417792
    buffer_load_dwordx4 v[152:155], v2, s[60:63], s82 offen offset:0 sc1
    buffer_load_dwordx4 v[156:159], v2, s[60:63], s82 offen offset:1024 sc1
    s_add_u32 s82, s78, 557056
    buffer_load_dwordx4 v[160:163], v2, s[60:63], s82 offen offset:0 sc1
    buffer_load_dwordx4 v[164:167], v2, s[60:63], s82 offen offset:1024 sc1
    s_add_u32 s82, s78, 696320
    buffer_load_dwordx4 v[168:171], v2, s[60:63], s82 offen offset:0 sc1
    buffer_load_dwordx4 v[172:175], v2, s[60:63], s82 offen offset:1024 sc1
    s_add_u32 s82, s78, 835584
    buffer_load_dwordx4 v[176:179], v2, s[60:63], s82 offen offset:0 sc1
    buffer_load_dwordx4 v[180:183], v2, s[60:63], s82 offen offset:1024 sc1
    s_add_u32 s82, s78, 974848
    buffer_load_dwordx4 v[184:187], v2, s[60:63], s82 offen offset:0 sc1
    buffer_load_dwordx4 v[188:191], v2, s[60:63], s82 offen offset:1024 sc1
    s_waitcnt vmcnt(0)
    s_branch Lc_18
Lr_22:
    s_cmp_eq_u32 s84, 0
    s_cbranch_scc1 Lk_23
    s_sub_u32 s84, s84, 1
    s_nop 0
    s_add_u32 s82, s78, 557056
    buffer_load_dwordx4 v[160:163], v2, s[60:63], s82 offen offset:0 sc1
    buffer_load_dwordx4 v[164:167], v2, s[60:63], s82 offen offset:1024 sc1
    s_add_u32 s82, s78, 696320
    buffer_load_dwordx4 v[168:171], v2, s[60:63], s82 offen offset:0 sc1
    buffer_load_dwordx4 v[172:175], v2, s[60:63], s82 offen offset:1024 sc1
    s_add_u32 s82, s78, 835584
    buffer_load_dwordx4 v[176:179], v2, s[60:63], s82 offen offset:0 sc1
    buffer_load_dwordx4 v[180:183], v2, s[60:63], s82 offen offset:1024 sc1
    s_add_u32 s82, s78, 974848
    buffer_load_dwordx4 v[184:187], v2, s[60:63], s82 offen offset:0 sc1
    buffer_load_dwordx4 v[188:191], v2, s[60:63], s82 offen offset:1024 sc1
    s_waitcnt vmcnt(0)
    s_branch Lc_21
Lr_25:
    s_cmp_eq_u32 s84, 0
    s_cbranch_scc1 Lk_26
    s_sub_u32 s84, s84, 1
    s_add_u32 s82, s78, 835584
    buffer_load_dwordx4 v[176:179], v2, s[60:63], s82 offen offset:0 sc1
    buffer_load_dwordx4 v[180:183], v2, s[60:63], s82 offen offset:1024 sc1
    s_add_u32 s82, s78, 974848
    buffer_load_dwordx4 v[184:187], v2, s[60:63], s82 offen offset:0 sc1
    buffer_load_dwordx4 v[188:191], v2, s[60:63], s82 offen offset:1024 sc1
    s_waitcnt vmcnt(0)
    s_branch Lc_24
Lr_30:
    s_cmp_eq_u32 s84, 0
    s_cbranch_scc1 Lk_31
    s_sub_u32 s84, s84, 1
    s_mov_b32 s19, m0
    s_add_u32 m0, s87, 65536
    s_add_u32 s50, s76, 0
    buffer_load_dwordx4 v2, s[60:63], s50 offen offset:0 sc1 lds
    buffer_load_dwordx4 v2, s[60:63], s50 offen offset:1024 sc1 lds
    buffer_load_dwordx4 v2, s[60:63], s50 offen offset:2048 sc1 lds
    buffer_load_dwordx4 v2, s[60:63], s50 offen offset:3072 sc1 lds
    s_add_u32 m0, s87, 69632
    s_add_u32 s50, s76, 4096
    buffer_load_dwordx4 v2, s[60:63], s50 offen offset:0 sc1 lds
    buffer_load_dwordx4 v2, s[60:63], s50 offen offset:1024 sc1 lds
    buffer_load_dwordx4 v2, s[60:63], s50 offen offset:2048 sc1 lds
    s_mov_b32 m0, s19
    s_waitcnt vmcnt(0)
    ds_read_b128 v[16:19], v255 offset:0
    ds_read_b128 v[20:23], v255 offset:1024
    ds_read_b128 v[24:27], v255 offset:2048
    ds_read_b128 v[28:31], v255 offset:3072
    ds_read_b128 v[32:35], v255 offset:4096
    ds_read_b128 v[36:39], v255 offset:5120
    ds_read_b128 v[40:43], v255 offset:6144
    s_waitcnt lgkmcnt(0)
    s_waitcnt vmcnt(0)
    s_branch Lc_29
Lr_33:
    s_cmp_eq_u32 s84, 0
    s_cbranch_scc1 Lk_34
    s_sub_u32 s84, s84, 1
    s_mov_b64 exec, 3
    buffer_load_dword v179, v176, s[60:63], s11 offen sc1
    s_mov_b64 exec, -1
    s_waitcnt vmcnt(0)
    s_branch Lc_32
Lr_36:
    s_cmp_eq_u32 s84, 0
    s_cbranch_scc1 Lk_37
    s_sub_u32 s84, s84, 1
    s_mov_b32 s19, m0
    s_add_u32 m0, s87, 98304
    s_add_u32 s50, s76, 28672
    buffer_load_dwordx4 v2, s[60:63], s50 offen offset:0 sc1 lds
    buffer_load_dwordx4 v2, s[60:63], s50 offen offset:1024 sc1 lds
    buffer_load_dwordx4 v2, s[60:63], s50 offen offset:2048 sc1 lds
    buffer_load_dwordx4 v2, s[60:63], s50 offen offset:3072 sc1 lds
    s_add_u32 m0, s87, 102400
    s_add_u32 s50, s76, 32768
    buffer_load_dwordx4 v2, s[60:63], s50 offen offset:0 sc1 lds
    buffer_load_dwordx4 v2, s[60:63], s50 offen offset:1024 sc1 lds
    buffer_load_dwordx4 v2, s[60:63], s50 offen offset:2048 sc1 lds
    s_mov_b32 m0, s19
    s_waitcnt vmcnt(0)
    ds_read_b128 v[16:19], v255 offset:32768
    ds_read_b128 v[20:23], v255 offset:33792
    ds_read_b128 v[24:27], v255 offset:34816
    ds_read_b128 v[28:31], v255 offset:35840
    ds_read_b128 v[32:35], v255 offset:36864
    ds_read_b128 v[36:39], v255 offset:37888
    ds_read_b128 v[40:43], v255 offset:38912
    s_waitcnt lgkmcnt(0)
    s_waitcnt vmcnt(0)
    v_max3_u32 v111, v16, v20, v24
    v_max3_u32 v111, v111, v28, v32
    v_max3_u32 v111, v111, v36, v40
    v_cmp_eq_u32 vcc, -1, v111
    s_waitcnt vmcnt(0)
    s_branch Lc_35
Lr_39:
    s_cmp_eq_u32 s84, 0
    s_cbranch_scc1 Lk_40
    s_sub_u32 s84, s84, 1
    s_mov_b32 s19, m0
    s_add_u32 m0, s90, 4096
    s_add_u32 s50, s77, 0
    buffer_load_dwordx4 v2, s[60:63], s50 offen offset:0 sc1 lds
    buffer_load_dwordx4 v2, s[60:63], s50 offen offset:1024 sc1 lds
    buffer_load_dwordx4 v2, s[60:63], s50 offen offset:2048 sc1 lds
    buffer_load_dwordx4 v2, s[60:63], s50 offen offset:3072 sc1 lds
    s_mov_b32 m0, s19
    s_waitcnt vmcnt(0)
    ds_read2st64_b32 v[160:161], v112 offset0:0 offset1:1
    ds_read2st64_b32 v[162:163], v112 offset0:2 offset1:3
    ds_read2st64_b32 v[164:165], v112 offset0:4 offset1:5
    ds_read2st64_b32 v[166:167], v112 offset0:6 offset1:7
    ds_read2st64_b32 v[168:169], v112 offset0:8 offset1:9
    ds_read2st64_b32 v[170:171], v112 offset0:10 offset1:11
    ds_read2st64_b32 v[172:173], v112 offset0:12 offset1:13
    s_waitcnt lgkmcnt(0)
    s_waitcnt vmcnt(0)
    v_max3_u32 v252, v160, v161, v162
    v_max3_u32 v252, v252, v163, v164
    v_max3_u32 v252, v252, v165, v166
    v_max3_u32 v252, v252, v167, v168
    v_max3_u32 v252, v252, v169, v170
    v_max3_u32 v252, v252, v171, v172
    v_max_u32 v252, v252, v173
    v_cmp_eq_u32 vcc, -1, v252
    s_waitcnt vmcnt(0)
    s_branch Lc_38
Lr_44:
    s_cmp_eq_u32 s84, 0
    s_cbranch_scc1 Lk_45
    s_sub_u32 s84, s84, 1
    s_mov_b64 exec, 16383
    buffer_load_dword v253, v112, s[60:63], s20 offen sc1
    s_mov_b64 exec, -1
    s_waitcnt vmcnt(0)
    s_branch Lc_43
Lr_49:
    s_cmp_eq_u32 s84, 0
    s_cbranch_scc1 Lk_50
    s_sub_u32 s84, s84, 1
    s_mov_b64 exec, 65535
    buffer_load_dword v12, v115, s[60:63], s14 offen sc1
    s_mov_b64 exec, -1
    s_waitcnt vmcnt(0)
    s_branch Lc_48
Lr_52:
    s_cmp_eq_u32 s84, 0
    s_cbranch_scc1 Lk_53
    s_sub_u32 s84, s84, 1
    s_add_u32 s21, s79, 0
    buffer_load_dwordx4 a[0:3], v3, s[60:63], s21 offen offset:0 sc1
    buffer_load_dwordx4 a[4:7], v3, s[60:63], s21 offen offset:256 sc1
    buffer_load_dwordx4 a[8:11], v3, s[60:63], s21 offen offset:2048 sc1
    buffer_load_dwordx4 a[12:15], v3, s[60:63], s21 offen offset:2304 sc1
    s_add_u32 s21, s79, 4096
    buffer_load_dwordx4 a[16:19], v3, s[60:63], s21 offen offset:0 sc1
    buffer_load_dwordx4 a[20:23], v3, s[60:63], s21 offen offset:256 sc1
    buffer_load_dwordx4 a[24:27], v3, s[60:63], s21 offen offset:2048 sc1
    buffer_load_dwordx4 a[28:31], v3, s[60:63], s21 offen offset:2304 sc1
    s_add_u32 s21, s79, 8192
    buffer_load_dwordx4 a[32:35], v3, s[60:63], s21 offen offset:0 sc1
    buffer_load_dwordx4 a[36:39], v3, s[60:63], s21 offen offset:256 sc1
    s_waitcnt vmcnt(0)
    v_accvgpr_read_b32 v116, a0
    v_accvgpr_read_b32 v117, a4
    v_accvgpr_read_b32 v118, a8
    v_accvgpr_read_b32 v119, a12
    v_max3_u32 v252, v116, v117, v118
    v_max_u32 v252, v252, v119
    v_cmp_eq_u32 vcc, -1, v252
    s_waitcnt vmcnt(0)
    s_branch Lc_51
Lr_55:
    s_cmp_eq_u32 s84, 0
    s_cbranch_scc1 Lk_56
    s_sub_u32 s84, s84, 1
    s_add_u32 s21, s79, 4096
    buffer_load_dwordx4 a[16:19], v3, s[60:63], s21 offen offset:0 sc1
    buffer_load_dwordx4 a[20:23], v3, s[60:63], s21 offen offset:256 sc1
    buffer_load_dwordx4 a[24:27], v3, s[60:63], s21 offen offset:2048 sc1
    buffer_load_dwordx4 a[28:31], v3, s[60:63], s21 offen offset:2304 sc1
    s_add_u32 s21, s79, 8192
    buffer_load_dwordx4 a[32:35], v3, s[60:63], s21 offen offset:0 sc1
    buffer_load_dwordx4 a[36:39], v3, s[60:63], s21 offen offset:256 sc1
    buffer_load_dwordx4 a[40:43], v3, s[60:63], s21 offen offset:2048 sc1
    buffer_load_dwordx4 a[44:47], v3, s[60:63], s21 offen offset:2304 sc1
    s_add_u32 s21, s79, 12288
    buffer_load_dwordx4 a[48:51], v3, s[60:63], s21 offen offset:0 sc1
    buffer_load_dwordx4 a[52:55], v3, s[60:63], s21 offen offset:256 sc1
    s_waitcnt vmcnt(0)
    v_accvgpr_read_b32 v244, a16
    v_accvgpr_read_b32 v245, a20
    v_accvgpr_read_b32 v246, a24
    v_accvgpr_read_b32 v247, a28
    v_max3_u32 v252, v244, v245, v246
    v_max_u32 v252, v252, v247
    v_cmp_eq_u32 vcc, -1, v252
    s_waitcnt vmcnt(0)
    s_branch Lc_54
Lr_58:
    s_cmp_eq_u32 s84, 0
    s_cbranch_scc1 Lk_59
    s_sub_u32 s84, s84, 1
    s_add_u32 s21, s79, 8192
    buffer_load_dwordx4 a[32:35], v3, s[60:63], s21 offen offset:0 sc1
    buffer_load_dwordx4 a[36:39], v3, s[60:63], s21 offen offset:256 sc1
    buffer_load_dwordx4 a[40:43], v3, s[60:63], s21 offen offset:2048 sc1
    buffer_load_dwordx4 a[44:47], v3, s[60:63], s21 offen offset:2304 sc1
    s_add_u32 s21, s79, 12288
    buffer_load_dwordx4 a[48:51], v3, s[60:63], s21 offen offset:0 sc1
    buffer_load_dwordx4 a[52:55], v3, s[60:63], s21 offen offset:256 sc1
    s_add_u32 s21, s79, 57344
    buffer_load_dwordx4 a[56:59], v3, s[60:63], s21 offen offset:0 sc1
    buffer_load_dwordx4 a[60:63], v3, s[60:63], s21 offen offset:256 sc1
    buffer_load_dwordx4 a[64:67], v3, s[60:63], s21 offen offset:2048 sc1
    buffer_load_dwordx4 a[68:71], v3, s[60:63], s21 offen offset:2304 sc1
    s_waitcnt vmcnt(0)
    v_accvgpr_read_b32 v244, a32
    v_accvgpr_read_b32 v245, a36
    v_accvgpr_read_b32 v246, a40
    v_accvgpr_read_b32 v247, a44
    v_max3_u32 v252, v244, v245, v246
    v_max_u32 v252, v252, v247
    v_cmp_eq_u32 vcc, -1, v252
    s_waitcnt vmcnt(0)
    s_branch Lc_57
Lr_61:
    s_cmp_eq_u32 s84, 0
    s_cbranch_scc1 Lk_62
    s_sub_u32 s84, s84, 1
    s_add_u32 s21, s79, 12288
    buffer_load_dwordx4 a[48:51], v3, s[60:63], s21 offen offset:0 sc1
    buffer_load_dwordx4 a[52:55], v3, s[60:63], s21 offen offset:256 sc1
    s_add_u32 s21, s79, 57344
    buffer_load_dwordx4 a[56:59], v3, s[60:63], s21 offen offset:0 sc1
    buffer_load_dwordx4 a[60:63], v3, s[60:63], s21 offen offset:256 sc1
    buffer_load_dwordx4 a[64:67], v3, s[60:63], s21 offen offset:2048 sc1
    buffer_load_dwordx4 a[68:71], v3, s[60:63], s21 offen offset:2304 sc1
    s_add_u32 s21, s79, 61440
    buffer_load_dwordx4 a[72:75], v3, s[60:63], s21 offen offset:0 sc1
    buffer_load_dwordx4 a[76:79], v3, s[60:63], s21 offen offset:256 sc1
    buffer_load_dwordx4 a[80:83], v3, s[60:63], s21 offen offset:2048 sc1
    buffer_load_dwordx4 a[84:87], v3, s[60:63], s21 offen offset:2304 sc1
    s_waitcnt vmcnt(0)
    v_accvgpr_read_b32 v244, a48
    v_accvgpr_read_b32 v245, a52
    v_accvgpr_read_b32 v246, a56
    v_accvgpr_read_b32 v247, a60
    v_max3_u32 v252, v244, v245, v246
    v_max_u32 v252, v252, v247
    v_cmp_eq_u32 vcc, -1, v252
    s_waitcnt vmcnt(0)
    s_branch Lc_60
Lr_64:
    s_cmp_eq_u32 s84, 0
    s_cbranch_scc1 Lk_65
    s_sub_u32 s84, s84, 1
    s_add_u32 s21, s79, 57344
    buffer_load_dwordx4 a[64:67], v3, s[60:63], s21 offen offset:2048 sc1
    buffer_load_dwordx4 a[68:71], v3, s[60:63], s21 offen offset:2304 sc1
    s_add_u32 s21, s79, 61440
    buffer_load_dwordx4 a[72:75], v3, s[60:63], s21 offen offset:0 sc1
    buffer_load_dwordx4 a[76:79], v3, s[60:63], s21 offen offset:256 sc1
    buffer_load_dwordx4 a[80:83], v3, s[60:63], s21 offen offset:2048 sc1
    buffer_load_dwordx4 a[84:87], v3, s[60:63], s21 offen offset:2304 sc1
    s_add_u32 s21, s79, 65536
    buffer_load_dwordx4 a[88:91], v3, s[60:63], s21 offen offset:0 sc1
    buffer_load_dwordx4 a[92:95], v3, s[60:63], s21 offen offset:256 sc1
    buffer_load_dwordx4 a[96:99], v3, s[60:63], s21 offen offset:2048 sc1
    buffer_load_dwordx4 a[100:103], v3, s[60:63], s21 offen offset:2304 sc1
    s_waitcnt vmcnt(0)
    v_accvgpr_read_b32 v244, a64
    v_accvgpr_read_b32 v245, a68
    v_accvgpr_read_b32 v246, a72
    v_accvgpr_read_b32 v247, a76
    v_max3_u32 v252, v244, v245, v246
    v_max_u32 v252, v252, v247
    v_cmp_eq_u32 vcc, -1, v252
    s_waitcnt vmcnt(0)
    s_branch Lc_63
Lr_67:
    s_cmp_eq_u32 s84, 0
    s_cbranch_scc1 Lk_68
    s_sub_u32 s84, s84, 1
    s_add_u32 s21, s79, 61440
    buffer_load_dwordx4 a[80:83], v3, s[60:63], s21 offen offset:2048 sc1
    buffer_load_dwordx4 a[84:87], v3, s[60:63], s21 offen offset:2304 sc1
    s_add_u32 s21, s79, 65536
    buffer_load_dwordx4 a[88:91], v3, s[60:63], s21 offen offset:0 sc1
    buffer_load_dwordx4 a[92:95], v3, s[60:63], s21 offen offset:256 sc1
    buffer_load_dwordx4 a[96:99], v3, s[60:63], s21 offen offset:2048 sc1
    buffer_load_dwordx4 a[100:103], v3, s[60:63], s21 offen offset:2304 sc1
    s_add_u32 s21, s79, 69632
    buffer_load_dwordx4 a[104:107], v3, s[60:63], s21 offen offset:0 sc1
    buffer_load_dwordx4 a[108:111], v3, s[60:63], s21 offen offset:256 sc1
    s_waitcnt vmcnt(0)
    v_accvgpr_read_b32 v244, a80
    v_accvgpr_read_b32 v245, a84
    v_accvgpr_read_b32 v246, a88
    v_accvgpr_read_b32 v247, a92
    v_max3_u32 v252, v244, v245, v246
    v_max_u32 v252, v252, v247
    v_cmp_eq_u32 vcc, -1, v252
    s_waitcnt vmcnt(0)
    s_branch Lc_66
Lr_70:
    s_cmp_eq_u32 s84, 0
    s_cbranch_scc1 Lk_71
    s_sub_u32 s84, s84, 1
    s_add_u32 s21, s79, 65536
    buffer_load_dwordx4 a[96:99], v3, s[60:63], s21 offen offset:2048 sc1
    buffer_load_dwordx4 a[100:103], v3, s[60:63], s21 offen offset:2304 sc1
    s_add_u32 s21, s79, 69632
    buffer_load_dwordx4 a[104:107], v3, s[60:63], s21 offen offset:0 sc1
    buffer_load_dwordx4 a[108:111], v3, s[60:63], s21 offen offset:256 sc1
    s_waitcnt vmcnt(0)
    v_accvgpr_read_b32 v244, a96
    v_accvgpr_read_b32 v245, a100
    v_accvgpr_read_b32 v246, a104
    v_accvgpr_read_b32 v247, a108
    v_max3_u32 v252, v244, v245, v246
    v_max_u32 v252, v252, v247
    v_cmp_eq_u32 vcc, -1, v252
    s_waitcnt vmcnt(0)
    s_branch Lc_69
Lr_73:
    s_cmp_eq_u32 s84, 0
    s_cbranch_scc1 Lk_74
    s_sub_u32 s84, s84, 1
    s_add_u32 s21, s79, 229376
    buffer_load_dwordx4 a[0:3], v3, s[60:63], s21 offen offset:0 sc1
    buffer_load_dwordx4 a[4:7], v3, s[60:63], s21 offen offset:256 sc1
    buffer_load_dwordx4 a[8:11], v3, s[60:63], s21 offen offset:2048 sc1
    buffer_load_dwordx4 a[12:15], v3, s[60:63], s21 offen offset:2304 sc1
    s_add_u32 s21, s79, 233472
    buffer_load_dwordx4 a[16:19], v3, s[60:63], s21 offen offset:0 sc1
    buffer_load_dwordx4 a[20:23], v3, s[60:63], s21 offen offset:256 sc1
    buffer_load_dwordx4 a[24:27], v3, s[60:63], s21 offen offset:2048 sc1
    buffer_load_dwordx4 a[28:31], v3, s[60:63], s21 offen offset:2304 sc1
    s_add_u32 s21, s79, 237568
    buffer_load_dwordx4 a[32:35], v3, s[60:63], s21 offen offset:0 sc1
    buffer_load_dwordx4 a[36:39], v3, s[60:63], s21 offen offset:256 sc1
    s_waitcnt vmcnt(0)
    v_accvgpr_read_b32 v244, a0
    v_accvgpr_read_b32 v245, a4
    v_accvgpr_read_b32 v246, a8
    v_accvgpr_read_b32 v247, a12
    v_max3_u32 v252, v244, v245, v246
    v_max_u32 v252, v252, v247
    v_cmp_eq_u32 vcc, -1, v252
    s_waitcnt vmcnt(0)
    s_branch Lc_72
Lr_76:
    s_cmp_eq_u32 s84, 0
    s_cbranch_scc1 Lk_77
    s_sub_u32 s84, s84, 1
    s_add_u32 s21, s79, 233472
    buffer_load_dwordx4 a[16:19], v3, s[60:63], s21 offen offset:0 sc1
    buffer_load_dwordx4 a[20:23], v3, s[60:63], s21 offen offset:256 sc1
    buffer_load_dwordx4 a[24:27], v3, s[60:63], s21 offen offset:2048 sc1
    buffer_load_dwordx4 a[28:31], v3, s[60:63], s21 offen offset:2304 sc1
    s_add_u32 s21, s79, 237568
    buffer_load_dwordx4 a[32:35], v3, s[60:63], s21 offen offset:0 sc1
    buffer_load_dwordx4 a[36:39], v3, s[60:63], s21 offen offset:256 sc1
    buffer_load_dwordx4 a[40:43], v3, s[60:63], s21 offen offset:2048 sc1
    buffer_load_dwordx4 a[44:47], v3, s[60:63], s21 offen offset:2304 sc1
    s_add_u32 s21, s79, 241664
    buffer_load_dwordx4 a[48:51], v3, s[60:63], s21 offen offset:0 sc1
    buffer_load_dwordx4 a[52:55], v3, s[60:63], s21 offen offset:256 sc1
    s_waitcnt vmcnt(0)
    v_accvgpr_read_b32 v244, a16
    v_accvgpr_read_b32 v245, a20
    v_accvgpr_read_b32 v246, a24
    v_accvgpr_read_b32 v247, a28
    v_max3_u32 v252, v244, v245, v246
    v_max_u32 v252, v252, v247
    v_cmp_eq_u32 vcc, -1, v252
    s_waitcnt vmcnt(0)
    s_branch Lc_75
Lr_79:
    s_cmp_eq_u32 s84, 0
    s_cbranch_scc1 Lk_80
    s_sub_u32 s84, s84, 1
    s_add_u32 s21, s79, 237568
    buffer_load_dwordx4 a[32:35], v3, s[60:63], s21 offen offset:0 sc1
    buffer_load_dwordx4 a[36:39], v3, s[60:63], s21 offen offset:256 sc1
    buffer_load_dwordx4 a[40:43], v3, s[60:63], s21 offen offset:2048 sc1
    buffer_load_dwordx4 a[44:47], v3, s[60:63], s21 offen offset:2304 sc1
    s_add_u32 s21, s79, 241664
    buffer_load_dwordx4 a[48:51], v3, s[60:63], s21 offen offset:0 sc1
    buffer_load_dwordx4 a[52:55], v3, s[60:63], s21 offen offset:256 sc1
    s_add_u32 s21, s79, 286720
    buffer_load_dwordx4 a[56:59], v3, s[60:63], s21 offen offset:0 sc1
    buffer_load_dwordx4 a[60:63], v3, s[60:63], s21 offen offset:256 sc1
    buffer_load_dwordx4 a[64:67], v3, s[60:63], s21 offen offset:2048 sc1
    buffer_load_dwordx4 a[68:71], v3, s[60:63], s21 offen offset:2304 sc1
    s_waitcnt vmcnt(0)
    v_accvgpr_read_b32 v244, a32
    v_accvgpr_read_b32 v245, a36
    v_accvgpr_read_b32 v246, a40
    v_accvgpr_read_b32 v247, a44
    v_max3_u32 v252, v244, v245, v246
    v_max_u32 v252, v252, v247
    v_cmp_eq_u32 vcc, -1, v252
    s_waitcnt vmcnt(0)
    s_branch Lc_78
Lr_82:
    s_cmp_eq_u32 s84, 0
    s_cbranch_scc1 Lk_83
    s_sub_u32 s84, s84, 1
    s_add_u32 s21, s79, 241664
    buffer_load_dwordx4 a[48:51], v3, s[60:63], s21 offen offset:0 sc1
    buffer_load_dwordx4 a[52:55], v3, s[60:63], s21 offen offset:256 sc1
    s_add_u32 s21, s79, 286720
    buffer_load_dwordx4 a[56:59], v3, s[60:63], s21 offen offset:0 sc1
    buffer_load_dwordx4 a[60:63], v3, s[60:63], s21 offen offset:256 sc1
    buffer_load_dwordx4 a[64:67], v3, s[60:63], s21 offen offset:2048 sc1
    buffer_load_dwordx4 a[68:71], v3, s[60:63], s21 offen offset:2304 sc1
    s_add_u32 s21, s79, 290816
    buffer_load_dwordx4 a[72:75], v3, s[60:63], s21 offen offset:0 sc1
    buffer_load_dwordx4 a[76:79], v3, s[60:63], s21 offen offset:256 sc1
    buffer_load_dwordx4 a[80:83], v3, s[60:63], s21 offen offset:2048 sc1
    buffer_load_dwordx4 a[84:87], v3, s[60:63], s21 offen offset:2304 sc1
    s_waitcnt vmcnt(0)
    v_accvgpr_read_b32 v244, a48
    v_accvgpr_read_b32 v245, a52
    v_accvgpr_read_b32 v246, a56
    v_accvgpr_read_b32 v247, a60
    v_max3_u32 v252, v244, v245, v246
    v_max_u32 v252, v252, v247
    v_cmp_eq_u32 vcc, -1, v252
    s_waitcnt vmcnt(0)
    s_branch Lc_81
Lr_85:
    s_cmp_eq_u32 s84, 0
    s_cbranch_scc1 Lk_86
    s_sub_u32 s84, s84, 1
    s_add_u32 s21, s79, 286720
    buffer_load_dwordx4 a[64:67], v3, s[60:63], s21 offen offset:2048 sc1
    buffer_load_dwordx4 a[68:71], v3, s[60:63], s21 offen offset:2304 sc1
    s_add_u32 s21, s79, 290816
    buffer_load_dwordx4 a[72:75], v3, s[60:63], s21 offen offset:0 sc1
    buffer_load_dwordx4 a[76:79], v3, s[60:63], s21 offen offset:256 sc1
    buffer_load_dwordx4 a[80:83], v3, s[60:63], s21 offen offset:2048 sc1
    buffer_load_dwordx4 a[84:87], v3, s[60:63], s21 offen offset:2304 sc1
    s_add_u32 s21, s79, 294912
    buffer_load_dwordx4 a[88:91], v3, s[60:63], s21 offen offset:0 sc1
    buffer_load_dwordx4 a[92:95], v3, s[60:63], s21 offen offset:256 sc1
    buffer_load_dwordx4 a[96:99], v3, s[60:63], s21 offen offset:2048 sc1
    buffer_load_dwordx4 a[100:103], v3, s[60:63], s21 offen offset:2304 sc1
    s_waitcnt vmcnt(0)
    v_accvgpr_read_b32 v244, a64
    v_accvgpr_read_b32 v245, a68
    v_accvgpr_read_b32 v246, a72
    v_accvgpr_read_b32 v247, a76
    v_max3_u32 v252, v244, v245, v246
    v_max_u32 v252, v252, v247
    v_cmp_eq_u32 vcc, -1, v252
    s_waitcnt vmcnt(0)
    s_branch Lc_84
Lr_88:
    s_cmp_eq_u32 s84, 0
    s_cbranch_scc1 Lk_89
    s_sub_u32 s84, s84, 1
    s_add_u32 s21, s79, 290816
    buffer_load_dwordx4 a[80:83], v3, s[60:63], s21 offen offset:2048 sc1
    buffer_load_dwordx4 a[84:87], v3, s[60:63], s21 offen offset:2304 sc1
    s_add_u32 s21, s79, 294912
    buffer_load_dwordx4 a[88:91], v3, s[60:63], s21 offen offset:0 sc1
    buffer_load_dwordx4 a[92:95], v3, s[60:63], s21 offen offset:256 sc1
    buffer_load_dwordx4 a[96:99], v3, s[60:63], s21 offen offset:2048 sc1
    buffer_load_dwordx4 a[100:103], v3, s[60:63], s21 offen offset:2304 sc1
    s_add_u32 s21, s79, 299008
    buffer_load_dwordx4 a[104:107], v3, s[60:63], s21 offen offset:0 sc1
    buffer_load_dwordx4 a[108:111], v3, s[60:63], s21 offen offset:256 sc1
    s_waitcnt vmcnt(0)
    v_accvgpr_read_b32 v244, a80
    v_accvgpr_read_b32 v245, a84
    v_accvgpr_read_b32 v246, a88
    v_accvgpr_read_b32 v247, a92
    v_max3_u32 v252, v244, v245, v246
    v_max_u32 v252, v252, v247
    v_cmp_eq_u32 vcc, -1, v252
    s_waitcnt vmcnt(0)
    s_branch Lc_87
Lr_91:
    s_cmp_eq_u32 s84, 0
    s_cbranch_scc1 Lk_92
    s_sub_u32 s84, s84, 1
    s_add_u32 s21, s79, 294912
    buffer_load_dwordx4 a[96:99], v3, s[60:63], s21 offen offset:2048 sc1
    buffer_load_dwordx4 a[100:103], v3, s[60:63], s21 offen offset:2304 sc1
    s_add_u32 s21, s79, 299008
    buffer_load_dwordx4 a[104:107], v3, s[60:63], s21 offen offset:0 sc1
    buffer_load_dwordx4 a[108:111], v3, s[60:63], s21 offen offset:256 sc1
    s_waitcnt vmcnt(0)
    v_accvgpr_read_b32 v244, a96
    v_accvgpr_read_b32 v245, a100
    v_accvgpr_read_b32 v246, a104
    v_accvgpr_read_b32 v247, a108
    v_max3_u32 v252, v244, v245, v246
    v_max_u32 v252, v252, v247
    v_cmp_eq_u32 vcc, -1, v252
    s_waitcnt vmcnt(0)
    s_branch Lc_90
    .fill 2560, 4, 0xbf810000

.section .rodata,"a"
.p2align 6
.amdhsa_kernel sequential_preLN__linear_kernel_hedgehog__swiglu_ffn__prompt_kernel
  .amdhsa_next_free_vgpr 512
  .amdhsa_next_free_sgpr 102
  .amdhsa_accum_offset 256
  .amdhsa_group_segment_fixed_size 0
  .amdhsa_kernarg_size 88
  .amdhsa_user_sgpr_count 2
  .amdhsa_user_sgpr_kernarg_segment_ptr 1
  .amdhsa_system_sgpr_workgroup_id_x 1
.end_amdhsa_kernel
```
